```python
import torch

def _softmax(x, axis=-1):
    return torch.softmax(x, dim=axis)

def _gelu(x):
    return torch.nn.functional.gelu(x, approximate='tanh')

def _silu(x):
    return torch.nn.functional.silu(x)

def _sigmoid(x):
    return torch.sigmoid(x)

def _layernorm(x, axis=-1, eps=1e-05):
    m = x.mean(dim=axis, keepdim=True)
    v = x.var(dim=axis, keepdim=True, unbiased=False)
    return (x - m) / torch.sqrt(v + eps)

def _scatter_add(tgt, idx, src, axis=0):
    return tgt.clone().index_add_(axis, idx, src)

def _segment_sum(src, seg, n):
    out = torch.zeros((n,) + src.shape[1:], dtype=src.dtype)
    return out.index_add_(0, seg, src)

def _pad(x, pw):
    flat = tuple((v for pair in reversed(pw) for v in pair))
    return torch.nn.functional.pad(x, flat)
kernel_name = 'adaLN_cond__spectral_fnet__geglu_ffn__prompt'

def setup_inputs():

    _w = lambda a: (lambda t: t.to(torch.bfloat16) if t.is_floating_point() else t)(torch.as_tensor(a))

    def _A_setup():
        B, S, D = (1, 2048, 448)
        ns = torch.arange(S)[:, None] * torch.arange(S)[None, :]
        nd = torch.arange(D)[:, None] * torch.arange(D)[None, :]
        Ws_re = torch.cos(-2.0 * torch.pi * ns / S).to(float)
        Ws_im = torch.sin(-2.0 * torch.pi * ns / S).to(float)
        Wd_re = torch.cos(-2.0 * torch.pi * nd / D).to(float)
        Wd_im = torch.sin(-2.0 * torch.pi * nd / D).to(float)
        return {'x': _w((lambda *s: torch.randn(*s, dtype=torch.bfloat16) * 0.05)(B, S, D)), 'dft_seq_re': _w(Ws_re), 'dft_seq_im': _w(Ws_im), 'dft_hid_re': _w(Wd_re), 'dft_hid_im': _w(Wd_im)}
    _A_in = _A_setup()

    def _B_setup():
        B, S, D, F = (1, 2048, 448, 1792)
        return {'x': _w((lambda *s: torch.randn(*s, dtype=torch.bfloat16) * 0.05)(B, S, D)), 'w_gate': _w((lambda *s: torch.randn(*s, dtype=torch.bfloat16) * 0.4)(D, F)), 'w_up': _w((lambda *s: torch.randn(*s, dtype=torch.bfloat16) * 0.4)(D, F)), 'w_down': _w((lambda *s: torch.randn(*s, dtype=torch.bfloat16) * 0.4)(F, D))}
    _B_in = _B_setup()
    return {'A_x': _A_in['x'], 'A_dft_seq_re': _A_in['dft_seq_re'], 'A_dft_seq_im': _A_in['dft_seq_im'], 'A_dft_hid_re': _A_in['dft_hid_re'], 'A_dft_hid_im': _A_in['dft_hid_im'], 'B_x': _B_in['x'], 'B_w_gate': _B_in['w_gate'], 'B_w_up': _B_in['w_up'], 'B_w_down': _B_in['w_down'], 'c': _w((lambda *s: torch.randn(*s, dtype=torch.bfloat16) * 0.2)(1, 448) * 8.0), 'w_mod': _w((lambda *s: torch.randn(*s, dtype=torch.bfloat16) * 0.2)(448, 6 * 448) * 448 ** (-0.5) * 8.0)}

def reference(A_x, A_dft_seq_re, A_dft_seq_im, A_dft_hid_re, A_dft_hid_im, B_x, B_w_gate, B_w_up, B_w_down, c, w_mod):

    def _A_ref(x, dft_seq_re, dft_seq_im, dft_hid_re, dft_hid_im):
        a = torch.einsum('bsd,ed->bse', x, dft_hid_re)
        b = torch.einsum('bsd,ed->bse', x, dft_hid_im)
        y = torch.einsum('ts,bse->bte', dft_seq_re, a) - torch.einsum('ts,bse->bte', dft_seq_im, b)
        return y

    def _B_ref(x, w_gate, w_up, w_down):
        return _gelu(x @ w_gate) * (x @ w_up) @ w_down
    x = A_x
    mod = (_silu(c) @ w_mod).reshape(c.shape[0], 6, 1, -1)
    sa, ca, ga, sb, cb, gb = (mod[:, 0].clone(), mod[:, 1].clone(), mod[:, 2].clone(), mod[:, 3].clone(), mod[:, 4].clone(), mod[:, 5].clone())
    h = _layernorm(x, axis=-1) * (1 + ca) + sa
    x = x + ga * _A_ref(h, A_dft_seq_re, A_dft_seq_im, A_dft_hid_re, A_dft_hid_im)
    h = _layernorm(x, axis=-1) * (1 + cb) + sb
    x = x + gb * _B_ref(h, B_w_gate, B_w_up, B_w_down)
    return x
```

```asm
; @launch grid=(256,1,1) block=(512,1,1) lds=163840
.amdgcn_target "amdgcn-amd-amdhsa--gfx950"
.text
.globl adaLN_cond__spectral_fnet__geglu_ffn__prompt_kernel
.p2align 8
.type adaLN_cond__spectral_fnet__geglu_ffn__prompt_kernel,@function
adaLN_cond__spectral_fnet__geglu_ffn__prompt_kernel:
    s_cmp_ge_u32 s2, 256
    s_cbranch_scc1 KB_end
    s_load_dwordx2 s[4:5], s[0:1], 0
    s_load_dwordx4 s[44:47], s[0:1], 72
    s_load_dwordx2 s[6:7], s[0:1], 104
    s_load_dwordx4 s[8:11], s[0:1], 48
    s_load_dwordx2 s[34:35], s[0:1], 64
    s_load_dwordx4 s[48:51], s[0:1], 88
    v_lshrrev_b32 v1, 6, v0
    v_and_b32_e64 v2, 63, v0
    v_readfirstlane_b32 s20, v1
    s_cmp_ge_u32 s2, 8
    s_cbranch_scc1 K1_nopf
    s_mov_b64 exec, 0
    s_cmp_eq_u32 s20, 1
    s_cbranch_scc1 K1_stub0
    s_cmp_eq_u32 s20, 2
    s_cbranch_scc1 K1_stub1
    s_cmp_eq_u32 s20, 3
    s_cbranch_scc1 K1_stub2
    s_cmp_eq_u32 s20, 4
    s_cbranch_scc1 K1_stub3
    s_cmp_eq_u32 s20, 5
    s_cbranch_scc1 K1_stub4
    s_cmp_eq_u32 s20, 6
    s_cbranch_scc1 K1_stub5
    s_cmp_eq_u32 s20, 7
    s_cbranch_scc1 K1_stub6
    s_cmp_lg_u32 s2, 0
    s_cbranch_scc1 K1_back
    s_memrealtime s[12:13]
    s_mov_b64 exec, 1
    v_mov_b32 v98, 0
    s_waitcnt lgkmcnt(0)
    s_or_b32 s26, s12, 1
    v_mov_b32_e64 v99, s26
    global_store_dword v98, v99, s[50:51] sc1
K1_back:
    s_mov_b64 exec, -1
K1_nopf:
    v_lshrrev_b32 v3, 3, v2
    v_and_b32 v4, 7, v2
    s_and_b32 s21, s2, 7
    s_lshr_b32 s22, s2, 3
    s_sub_u32 s22, s22, 1
    s_cmp_ge_u32 s22, 16
    s_cbranch_scc1 K1_other
    s_lshr_b32 s24, s22, 2
    s_lshl_b32 s25, s21, 1
    s_lshr_b32 s26, s24, 1
    s_add_u32 s25, s25, s26
    s_sub_u32 s26, 32, s25
    s_cmp_eq_u32 s25, 0
    s_cselect_b32 s26, 16, s26
    s_bitcmp1_b32 s24, 0
    s_cselect_b32 s23, s26, s25
    s_and_b32 s24, s22, 3
    v_mul_u32_u24 v5, 28672, v3
    v_lshl_add_u32 v5, v4, 4, v5
    s_lshl_b32 s25, s20, 8
    s_add_u32 s25, s25, s23
    s_mul_i32 s25, s25, 896
    s_lshl_b32 s36, s24, 8
    s_add_u32 s36, s36, s25
    s_add_u32 s37, s36, 128
    s_cmp_eq_u32 s24, 3
    s_cselect_b32 s37, s25, s37
    s_mov_b32 s14, 1835008
    s_mov_b32 s15, 0x00020000
    s_waitcnt lgkmcnt(0)
    s_mov_b32 s12, s4
    s_mov_b32 s13, s5
    buffer_load_dwordx4 v[32:35], v5, s[12:15], s36 offen
    buffer_load_dwordx4 v[36:39], v5, s[12:15], s37 offen
    s_lshl_b32 s52, s23, 2
    s_add_u32 s52, s52, s24
    s_lshl_b32 s52, s52, 7
    s_lshl_b32 s24, s24, 1
    s_add_u32 s27, s25, 896
    s_add_u32 s38, s37, 128
    s_cmp_eq_u32 s38, s27
    s_cselect_b32 s38, s25, s38
    s_add_u32 s39, s38, 128
    s_cmp_eq_u32 s39, s27
    s_cselect_b32 s39, s25, s39
    s_add_u32 s40, s39, 128
    s_cmp_eq_u32 s40, s27
    s_cselect_b32 s40, s25, s40
    s_add_u32 s41, s40, 128
    s_cmp_eq_u32 s41, s27
    s_cselect_b32 s41, s25, s41
    s_add_u32 s42, s41, 128
    s_cmp_eq_u32 s42, s27
    s_cselect_b32 s42, s25, s42
    v_and_b32 v6, 15, v2
    v_lshrrev_b32_e64 v7, 4, v2
    s_and_b32 s28, s20, 1
    s_lshl_b32 s28, s28, 4
    s_bfe_u32 s29, s20, 0x10001
    s_lshr_b32 s30, s20, 2
    v_add_u32 v8, s28, v6
    v_cvt_f32_u32 v9, v8
    s_cmp_eq_u32 s29, 1
    s_cselect_b32 s31, 0x3e800000, 0
K1_stub0:
    s_cbranch_execz K1_back
    s_nop 0
    v_mov_b32 v10, s31
    s_cselect_b32 s31, 0, -1
    v_cmp_eq_u32_e64 vcc, s31, v8
    v_mov_b32 v11, 0x42000000
    s_nop 0
    v_cndmask_b32 v9, v9, v11, vcc
    v_cndmask_b32 v10, v10, 0, vcc
    v_mul_f32 v9, 0x3c800000, v9
    v_lshlrev_b32 v11, 2, v7
    v_cvt_f32_u32 v11, v11
    v_fma_f32 v10, v11, v9, v10
    s_mov_b32 s16, s6
    s_mov_b32 s17, s7
    s_mov_b32 s18, 1835008
    s_mov_b32 s19, 0x00020000
    v_cos_f32_e64 v64, v10
    v_fmamk_f32 v65, v9, 0x3f800000, v10
    v_cos_f32_e64 v65, v65
    v_fmamk_f32 v66, v9, 0x40000000, v10
    v_cos_f32_e64 v66, v66
    v_fmamk_f32 v67, v9, 0x40400000, v10
    v_cos_f32_e64 v67, v67
    v_fmamk_f32 v68, v9, 0x41800000, v10
    v_cos_f32_e64 v68, v68
    v_fmamk_f32 v69, v9, 0x41880000, v10
    v_cos_f32_e64 v69, v69
    v_fmamk_f32 v70, v9, 0x41900000, v10
    v_cos_f32_e64 v70, v70
    v_fmamk_f32 v71, v9, 0x41980000, v10
    v_cos_f32_e64 v71, v71
    v_cvt_pk_bf16_f32 v16, v64, v65
    v_cvt_pk_bf16_f32 v17, v66, v67
    v_cvt_pk_bf16_f32 v18, v68, v69
    v_cvt_pk_bf16_f32 v19, v70, v71
    v_fmamk_f32 v64, v9, 0x42000000, v10
    v_cos_f32_e64 v64, v64
    v_fmamk_f32 v65, v9, 0x42040000, v10
    v_cos_f32_e64 v65, v65
    v_fmamk_f32 v66, v9, 0x42080000, v10
    v_cos_f32_e64 v66, v66
    v_fmamk_f32 v67, v9, 0x420c0000, v10
    v_cos_f32_e64 v67, v67
    v_fmamk_f32 v68, v9, 0x42400000, v10
    v_cos_f32_e64 v68, v68
    v_fmamk_f32 v69, v9, 0x42440000, v10
    v_cos_f32_e64 v69, v69
    v_fmamk_f32 v70, v9, 0x42480000, v10
    v_cos_f32_e64 v70, v70
    v_fmamk_f32 v71, v9, 0x424c0000, v10
    v_cos_f32_e64 v71, v71
    v_cvt_pk_bf16_f32 v20, v64, v65
    v_cvt_pk_bf16_f32 v21, v66, v67
    v_cvt_pk_bf16_f32 v22, v68, v69
    v_cvt_pk_bf16_f32 v23, v70, v71
    v_lshlrev_b32 v12, 1, v3
    v_and_b32 v12, 4, v12
    v_xor_b32 v12, v12, v4
    v_lshlrev_b32 v12, 4, v12
    v_lshl_add_u32 v12, v3, 7, v12
    s_lshl_b32 s31, s20, 10
    s_add_u32 s31, s31, 147456
    v_add_u32 v12, s31, v12
    v_lshrrev_b32_e64 v13, 2, v6
    v_lshl_add_u32 v13, v7, 2, v13
    v_lshlrev_b32 v14, 1, v13
    v_and_b32 v14, 4, v14
    v_and_b32 v15, 3, v6
    v_or_b32 v14, v14, v15
    v_lshlrev_b32_e64 v14, 4, v14
    v_lshl_add_u32 v13, v13, 7, v14
    s_lshl_b32 s31, s30, 13
    s_add_u32 s31, s31, 147456
    v_add_u32 v13, s31, v13
    v_xor_b32_e64 v15, 64, v13
    v_mul_u32_u24 v14, 57344, v3
    v_lshl_add_u32 v14, v4, 4, v14
    s_add_u32 s24, s24, s30
    s_mul_i32 s31, s29, 28672
    s_mul_i32 s32, s23, 896
    s_add_u32 s31, s31, s32
    s_lshl_b32 s32, s24, 7
    s_add_u32 s31, s31, s32
    s_mul_i32 s32, s28, 57344
    s_add_u32 s31, s31, s32
    s_add_u32 s32, s31, 458752
    s_mov_b32 s33, 0x3f803f80
    v_mov_b32 v24, 0
    v_mov_b32 v25, 0
    v_mov_b32 v26, 0
    v_mov_b32 v27, 0
    s_waitcnt vmcnt(0)
    buffer_load_dwordx4 v[40:43], v5, s[12:15], s38 offen
    buffer_load_dwordx4 v[44:47], v5, s[12:15], s39 offen
    buffer_load_dwordx4 v[48:51], v5, s[12:15], s40 offen
    buffer_load_dwordx4 v[52:55], v5, s[12:15], s41 offen
    buffer_load_dwordx4 v[56:59], v5, s[12:15], s42 offen
    s_lshr_b32 s60, s2, 5
    s_lshl_b32 s60, s60, 7
    s_mul_i32 s61, s20, 200704
    s_add_u32 s60, s60, s61
    s_and_b32 s61, s20, 3
    s_mul_i32 s56, s61, 28672
    s_lshl_b32 s61, s61, 13
    s_add_u32 s61, s61, 114688
    s_cmp_ge_u32 s20, 4
    s_cselect_b32 s61, s56, s61
    v_and_b32 v96, 6, v3
    v_xor_b32 v96, v96, v4
    v_lshlrev_b32 v96, 4, v96
    v_mul_u32_u24 v97, 896, v3
    v_add_u32_e64 v96, v96, v97
    s_mov_b32 s56, s34
    s_mov_b32 s57, s35
    s_mov_b32 s58, 1605632
    s_mov_b32 s59, 0x00020000
    s_add_u32 s29, s61, 6144
    v_xor_b32 v8, v7, v4
    v_lshlrev_b32 v8, 4, v8
    v_lshl_add_u32 v8, v6, 7, v8
    v_add_u32 v8, s29, v8
    v_xor_b32 v9, 64, v8
    v_xor_b32 v10, v3, v4
    v_lshlrev_b32 v10, 4, v10
    v_lshl_add_u32 v10, v3, 7, v10
    v_add_u32 v10, s29, v10
    v_dot2c_f32_bf16 v24, s33, v32
    v_dot2c_f32_bf16 v26, v32, v32
    v_dot2c_f32_bf16 v25, s33, v33
    v_dot2c_f32_bf16 v27, v33, v33
    v_dot2c_f32_bf16 v24, s33, v34
    v_dot2c_f32_bf16 v26, v34, v34
    v_dot2c_f32_bf16 v25, s33, v35
    v_dot2c_f32_bf16 v27, v35, v35
    v_lshlrev_b32 v64, 16, v32
    v_and_b32 v65, 0xffff0000, v32
    v_lshlrev_b32_e64 v66, 16, v33
    v_and_b32 v67, 0xffff0000, v33
    v_lshlrev_b32_e64 v68, 16, v34
    v_and_b32 v69, 0xffff0000, v34
    v_lshlrev_b32_e64 v70, 16, v35
    v_and_b32 v71, 0xffff0000, v35
    v_dot2c_f32_bf16 v24, s33, v36
    v_dot2c_f32_bf16 v26, v36, v36
    v_dot2c_f32_bf16 v25, s33, v37
    v_dot2c_f32_bf16 v27, v37, v37
    v_dot2c_f32_bf16 v24, s33, v38
    v_dot2c_f32_bf16 v26, v38, v38
    v_dot2c_f32_bf16 v25, s33, v39
    v_dot2c_f32_bf16 v27, v39, v39
    v_lshlrev_b32_e64 v72, 16, v36
    v_and_b32 v73, 0xffff0000, v36
    v_lshlrev_b32_e64 v74, 16, v37
    v_and_b32 v75, 0xffff0000, v37
    v_lshlrev_b32_e64 v76, 16, v38
    v_and_b32 v77, 0xffff0000, v38
    v_lshlrev_b32_e64 v78, 16, v39
    v_and_b32 v79, 0xffff0000, v39
    s_waitcnt vmcnt(4)
    v_dot2c_f32_bf16 v24, s33, v40
    v_dot2c_f32_bf16 v26, v40, v40
    v_dot2c_f32_bf16 v25, s33, v41
    v_dot2c_f32_bf16 v27, v41, v41
    v_dot2c_f32_bf16 v24, s33, v42
K1_stub1:
    s_cbranch_execz K1_back
    s_nop 0
    v_dot2c_f32_bf16 v26, v42, v42
    v_dot2c_f32_bf16 v25, s33, v43
    v_dot2c_f32_bf16 v27, v43, v43
    s_waitcnt vmcnt(3)
    v_dot2c_f32_bf16 v24, s33, v44
    v_dot2c_f32_bf16 v26, v44, v44
    v_dot2c_f32_bf16 v25, s33, v45
    v_dot2c_f32_bf16 v27, v45, v45
    v_dot2c_f32_bf16 v24, s33, v46
    v_dot2c_f32_bf16 v26, v46, v46
    v_dot2c_f32_bf16 v25, s33, v47
    v_dot2c_f32_bf16 v27, v47, v47
    s_waitcnt vmcnt(2)
    v_dot2c_f32_bf16 v24, s33, v48
    v_dot2c_f32_bf16 v26, v48, v48
    v_dot2c_f32_bf16 v25, s33, v49
    v_dot2c_f32_bf16 v27, v49, v49
    v_dot2c_f32_bf16 v24, s33, v50
    v_dot2c_f32_bf16 v26, v50, v50
    v_dot2c_f32_bf16 v25, s33, v51
    v_dot2c_f32_bf16 v27, v51, v51
    s_waitcnt vmcnt(1)
    v_dot2c_f32_bf16 v24, s33, v52
    v_dot2c_f32_bf16 v26, v52, v52
    v_dot2c_f32_bf16 v25, s33, v53
    v_dot2c_f32_bf16 v27, v53, v53
    v_dot2c_f32_bf16 v24, s33, v54
    v_dot2c_f32_bf16 v26, v54, v54
    v_dot2c_f32_bf16 v25, s33, v55
    v_dot2c_f32_bf16 v27, v55, v55
    s_waitcnt vmcnt(0)
    v_dot2c_f32_bf16 v24, s33, v56
    v_dot2c_f32_bf16 v26, v56, v56
    v_dot2c_f32_bf16 v25, s33, v57
    v_dot2c_f32_bf16 v27, v57, v57
    v_dot2c_f32_bf16 v24, s33, v58
    v_dot2c_f32_bf16 v26, v58, v58
    v_dot2c_f32_bf16 v25, s33, v59
    v_dot2c_f32_bf16 v27, v59, v59
    s_nop 1
    v_add_f32 v24, v24, v25
    v_add_f32_e64 v26, v26, v27
    s_nop 0
    v_add_f32_dpp v24, v24, v24 quad_perm:[1,0,3,2] row_mask:0xf bank_mask:0xf
    v_add_f32_dpp v26, v26, v26 quad_perm:[1,0,3,2] row_mask:0xf bank_mask:0xf
    s_nop 0
    v_add_f32_dpp v24, v24, v24 quad_perm:[2,3,0,1] row_mask:0xf bank_mask:0xf
    v_add_f32_dpp v26, v26, v26 quad_perm:[2,3,0,1] row_mask:0xf bank_mask:0xf
    s_nop 0
    v_add_f32_dpp v24, v24, v24 row_half_mirror row_mask:0xf bank_mask:0xf
    v_add_f32_dpp v26, v26, v26 row_half_mirror row_mask:0xf bank_mask:0xf
    v_mul_f32 v24, 0x3b124925, v24
    v_mov_b32 v27, 0x3727c5ac
    v_fmamk_f32 v26, v26, 0x3b124925, v27
    v_fma_f32 v26, -v24, v24, v26
    v_max_f32 v26, v26, v27
    v_rsq_f32 v25, v26
    s_nop 0
    v_mul_f32 v24, v24, v25
    v_pk_fma_f32 v[64:65], v[64:65], v[24:25], v[24:25] op_sel:[0,1,0] op_sel_hi:[1,1,0] neg_lo:[0,0,1] neg_hi:[0,0,1]
    v_pk_fma_f32 v[66:67], v[66:67], v[24:25], v[24:25] op_sel:[0,1,0] op_sel_hi:[1,1,0] neg_lo:[0,0,1] neg_hi:[0,0,1]
    v_pk_fma_f32 v[68:69], v[68:69], v[24:25], v[24:25] op_sel:[0,1,0] op_sel_hi:[1,1,0] neg_lo:[0,0,1] neg_hi:[0,0,1]
    v_pk_fma_f32 v[70:71], v[70:71], v[24:25], v[24:25] op_sel:[0,1,0] op_sel_hi:[1,1,0] neg_lo:[0,0,1] neg_hi:[0,0,1]
    v_cvt_pk_bf16_f32 v80, v64, v65
    v_cvt_pk_bf16_f32 v81, v66, v67
    v_cvt_pk_bf16_f32 v82, v68, v69
    v_cvt_pk_bf16_f32 v83, v70, v71
    ds_write_b128 v12, v[80:83] offset:0
    v_pk_fma_f32 v[72:73], v[72:73], v[24:25], v[24:25] op_sel:[0,1,0] op_sel_hi:[1,1,0] neg_lo:[0,0,1] neg_hi:[0,0,1]
    v_pk_fma_f32 v[74:75], v[74:75], v[24:25], v[24:25] op_sel:[0,1,0] op_sel_hi:[1,1,0] neg_lo:[0,0,1] neg_hi:[0,0,1]
    v_pk_fma_f32 v[76:77], v[76:77], v[24:25], v[24:25] op_sel:[0,1,0] op_sel_hi:[1,1,0] neg_lo:[0,0,1] neg_hi:[0,0,1]
    v_pk_fma_f32 v[78:79], v[78:79], v[24:25], v[24:25] op_sel:[0,1,0] op_sel_hi:[1,1,0] neg_lo:[0,0,1] neg_hi:[0,0,1]
    v_cvt_pk_bf16_f32 v84, v72, v73
    v_cvt_pk_bf16_f32 v85, v74, v75
    v_cvt_pk_bf16_f32 v86, v76, v77
    v_cvt_pk_bf16_f32 v87, v78, v79
    ds_write_b128 v12, v[84:87] offset:8192
    s_waitcnt lgkmcnt(0)
    s_barrier
    ds_read_b64_tr_b16 v[32:33], v13 offset:0
    ds_read_b64_tr_b16 v[34:35], v13 offset:2048
    ds_read_b64_tr_b16 v[36:37], v13 offset:4096
    ds_read_b64_tr_b16 v[38:39], v13 offset:6144
    ds_read_b64_tr_b16 v[40:41], v13 offset:8
    ds_read_b64_tr_b16 v[42:43], v13 offset:2056
    ds_read_b64_tr_b16 v[44:45], v13 offset:4104
    ds_read_b64_tr_b16 v[46:47], v13 offset:6152
    ds_read_b64_tr_b16 v[48:49], v15 offset:0
    ds_read_b64_tr_b16 v[50:51], v15 offset:2048
    ds_read_b64_tr_b16 v[52:53], v15 offset:4096
    ds_read_b64_tr_b16 v[54:55], v15 offset:6144
    ds_read_b64_tr_b16 v[56:57], v15 offset:8
    ds_read_b64_tr_b16 v[58:59], v15 offset:2056
    ds_read_b64_tr_b16 v[60:61], v15 offset:4104
    ds_read_b64_tr_b16 v[62:63], v15 offset:6152
    v_mov_b32_e64 v98, 0
    global_load_dword v99, v98, s[50:51] sc1
    s_cmp_lt_u32 s20, 4
    s_cbranch_scc1 AO_d1
AO_d1:
    s_cmp_eq_u32 s24, 7
    s_cbranch_scc1 K1_nost
    s_waitcnt lgkmcnt(12)
    v_mfma_f32_16x16x32_bf16 v[64:67], v[32:35], v[16:19], 0
    v_mfma_f32_16x16x32_bf16 v[64:67], v[36:39], v[20:23], v[64:67]
    s_waitcnt lgkmcnt(8)
    v_mfma_f32_16x16x32_bf16 v[68:71], v[40:43], v[16:19], 0
    v_mfma_f32_16x16x32_bf16 v[68:71], v[44:47], v[20:23], v[68:71]
    s_waitcnt lgkmcnt(4)
    v_mfma_f32_16x16x32_bf16 v[72:75], v[48:51], v[16:19], 0
    v_mfma_f32_16x16x32_bf16 v[72:75], v[52:55], v[20:23], v[72:75]
    s_waitcnt lgkmcnt(0)
    v_mfma_f32_16x16x32_bf16 v[76:79], v[56:59], v[16:19], 0
    v_mfma_f32_16x16x32_bf16 v[76:79], v[60:63], v[20:23], v[76:79]
    v_cvt_pk_bf16_f32 v80, v64, v65
    v_cvt_pk_bf16_f32 v81, v66, v67
    v_cvt_pk_bf16_f32 v82, v68, v69
    v_cvt_pk_bf16_f32 v83, v70, v71
    ds_write_b128 v8, v[80:83]
    v_cvt_pk_bf16_f32 v84, v72, v73
    v_cvt_pk_bf16_f32 v85, v74, v75
    s_nop 0
    v_cvt_pk_bf16_f32 v86, v76, v77
    v_cvt_pk_bf16_f32 v87, v78, v79
    ds_write_b128 v9, v[84:87]
    s_waitcnt lgkmcnt(0)
    ds_read_b128 v[88:91], v10
    ds_read_b128 v[92:95], v10 offset:1024
    s_waitcnt lgkmcnt(1)
    buffer_store_dwordx4 v[88:91], v14, s[16:19], s31 offen sc1
    s_waitcnt lgkmcnt(0)
    buffer_store_dwordx4 v[92:95], v14, s[16:19], s32 offen sc1
K1_nost:
    s_waitcnt lgkmcnt(0)
    s_cmp_lt_u32 s20, 4
    s_cbranch_scc1 AO_d2
    s_add_u32 m0, s61, 0
    s_add_u32 s28, s60, 7168
    buffer_load_dwordx4 v96, s[56:59], s60 offen lds
    s_add_u32 m0, s61, 1024
    s_add_u32 s60, s60, 14336
    buffer_load_dwordx4 v96, s[56:59], s28 offen lds
    s_add_u32 m0, s61, 2048
    s_add_u32 s28, s60, 7168
    buffer_load_dwordx4 v96, s[56:59], s60 offen lds
    s_add_u32 m0, s61, 3072
    s_add_u32 s60, s60, 14336
    buffer_load_dwordx4 v96, s[56:59], s28 offen lds
AO_d2:
    s_branch KS_W0
K1_other:
    s_cmp_ge_u32 s22, 22
    s_cbranch_scc1 K1_help
    s_cmp_ge_u32 s2, 178
    s_cbranch_scc1 K1_idle
    s_sub_u32 s21, s2, 136
    v_mul_u32_u24 v5, 5376, v3
    v_lshl_add_u32 v5, v4, 4, v5
    s_mul_i32 s25, s20, 301056
    s_lshl_b32 s26, s21, 7
    s_add_u32 s25, s25, s26
    s_add_u32 s52, s26, 16384
    v_lshlrev_b32_e64 v6, 1, v2
    s_mul_i32 s27, s20, 112
    v_mov_b32 v15, 0
    v_lshlrev_b32 v7, 2, v3
    v_bfe_u32 v10, v2, 4, 1
    v_lshrrev_b32_e64 v9, 5, v2
K1_stub2:
    s_cbranch_execz K1_back
    s_nop 0
    v_lshl_add_u32 v10, v10, 1, v9
    v_lshl_add_u32 v10, v4, 3, v10
    v_lshlrev_b32 v10, 2, v10
    s_lshl_b32 s28, s20, 8
    s_add_u32 s28, s28, 147456
    v_add_u32 v10, s28, v10
    s_waitcnt lgkmcnt(0)
    s_mov_b32 s12, s46
    s_mov_b32 s13, s47
    s_mov_b32 s14, 2408448
    s_mov_b32 s15, 0x00020000
    s_mov_b32 s16, s44
    s_mov_b32 s17, s45
    s_mov_b32 s18, 896
    s_mov_b32 s19, 0x00020000
    buffer_load_short_d16_hi v15, v6, s[16:19], s27 offen
    buffer_load_dwordx4 v[32:35], v5, s[12:15], s25 offen
    s_add_u32 s25, s25, 43008
    buffer_load_dwordx4 v[36:39], v5, s[12:15], s25 offen
    s_add_u32 s25, s25, 43008
    buffer_load_dwordx4 v[40:43], v5, s[12:15], s25 offen
    s_add_u32 s25, s25, 43008
    s_add_u32 s16, s6, 1835008
    s_addc_u32 s17, s7, 0
    s_mov_b32 s18, 12288
    s_mov_b32 s19, 0x00020000
    s_mul_i32 s31, s21, 37
    s_lshr_b32 s31, s31, 8
    s_mul_i32 s32, s31, 7
    s_sub_u32 s32, s21, s32
    s_lshl_b32 s32, s32, 6
    v_add_u32_e64 v11, s32, v2
    v_mul_u32_u24 v12, 9363, v11
    v_lshrrev_b32 v12, 16, v12
    v_mul_u32_u24 v13, 7, v12
    v_sub_u32 v13, v11, v13
    v_and_b32 v8, 15, v12
    v_lshrrev_b32 v12, 4, v12
    v_lshlrev_b32 v12, 7, v12
    v_lshl_add_u32 v12, v8, 2, v12
    v_and_b32 v8, 3, v13
    v_add_u32 v12, v12, v8
    v_lshrrev_b32_e64 v13, 2, v13
    v_lshl_add_u32 v12, v13, 6, v12
    s_sub_u32 s32, s31, 2
    s_cmp_lt_u32 s32, 3
    s_cselect_b64 vcc, -1, 0
    v_cndmask_b32 v12, v11, v12, vcc
    v_lshlrev_b32 v12, 2, v12
    s_lshl_b32 s32, s31, 2
    s_lshr_b32 s29, 0x523104, s32
    s_and_b32 s29, s29, 15
    s_lshl_b32 s29, s29, 11
    s_cmp_eq_u32 s31, 0
    s_cselect_b32 s30, 0x45000000, 1.0
    s_lshr_b32 s32, 0x12, s31
    s_bitcmp1_b32 s32, 0
    s_cselect_b32 s32, 1.0, 0
    v_mov_b32_e64 v13, s32
    s_lshr_b32 s60, s2, 5
    s_lshl_b32 s60, s60, 7
    s_mul_i32 s61, s20, 200704
    s_add_u32 s60, s60, s61
    s_and_b32 s61, s20, 3
    s_mul_i32 s56, s61, 28672
    s_lshl_b32 s61, s61, 13
    s_add_u32 s61, s61, 114688
    s_cmp_ge_u32 s20, 4
    s_cselect_b32 s61, s56, s61
    v_and_b32 v96, 6, v3
    v_xor_b32 v96, v96, v4
    v_lshlrev_b32 v96, 4, v96
    v_mul_u32_u24 v97, 896, v3
    v_add_u32_e64 v96, v96, v97
    s_mov_b32 s56, s34
    s_mov_b32 s57, s35
    s_mov_b32 s58, 1605632
    s_mov_b32 s59, 0x00020000
    s_waitcnt vmcnt(3)
    v_mul_f32 v14, 0xbfb8aa3b, v15
    v_exp_f32 v14, v14
    s_nop 0
    v_add_f32 v14, 1.0, v14
    v_rcp_f32 v14, v14
    s_nop 0
    v_mul_f32_e64 v15, v15, v14
    ds_bpermute_b32 v16, v7, v15 offset:0
    ds_bpermute_b32 v17, v7, v15 offset:32
    ds_bpermute_b32 v18, v7, v15 offset:64
    ds_bpermute_b32 v19, v7, v15 offset:96
    ds_bpermute_b32 v20, v7, v15 offset:128
    ds_bpermute_b32 v21, v7, v15 offset:160
    ds_bpermute_b32 v22, v7, v15 offset:192
    s_waitcnt vmcnt(0) lgkmcnt(0)
    buffer_load_dwordx4 v[44:47], v5, s[12:15], s25 offen
    s_add_u32 s25, s25, 43008
    buffer_load_dwordx4 v[48:51], v5, s[12:15], s25 offen
    s_add_u32 s25, s25, 43008
    buffer_load_dwordx4 v[52:55], v5, s[12:15], s25 offen
    s_add_u32 s25, s25, 43008
    buffer_load_dwordx4 v[56:59], v5, s[12:15], s25 offen
    s_add_u32 s25, s25, 43008
    v_lshlrev_b32 v24, 16, v32
    v_and_b32 v25, 0xffff0000, v32
    v_pk_mul_f32 v[64:65], v[24:25], v[16:17] op_sel:[0,0] op_sel_hi:[1,0]
    v_lshlrev_b32_e64 v26, 16, v33
    v_and_b32 v27, 0xffff0000, v33
    v_pk_mul_f32 v[66:67], v[26:27], v[16:17] op_sel:[0,0] op_sel_hi:[1,0]
    v_lshlrev_b32_e64 v24, 16, v34
    v_and_b32 v25, 0xffff0000, v34
    v_pk_mul_f32 v[68:69], v[24:25], v[16:17] op_sel:[0,0] op_sel_hi:[1,0]
    v_lshlrev_b32_e64 v26, 16, v35
    v_and_b32 v27, 0xffff0000, v35
    v_pk_mul_f32 v[70:71], v[26:27], v[16:17] op_sel:[0,0] op_sel_hi:[1,0]
    v_lshlrev_b32_e64 v24, 16, v36
    v_and_b32 v25, 0xffff0000, v36
    v_pk_fma_f32 v[64:65], v[24:25], v[16:17], v[64:65] op_sel:[0,1,0] op_sel_hi:[1,1,1]
    v_lshlrev_b32_e64 v26, 16, v37
    v_and_b32 v27, 0xffff0000, v37
    v_pk_fma_f32 v[66:67], v[26:27], v[16:17], v[66:67] op_sel:[0,1,0] op_sel_hi:[1,1,1]
    v_lshlrev_b32_e64 v24, 16, v38
    v_and_b32 v25, 0xffff0000, v38
    v_pk_fma_f32 v[68:69], v[24:25], v[16:17], v[68:69] op_sel:[0,1,0] op_sel_hi:[1,1,1]
    v_lshlrev_b32_e64 v26, 16, v39
    v_and_b32 v27, 0xffff0000, v39
    v_pk_fma_f32 v[70:71], v[26:27], v[16:17], v[70:71] op_sel:[0,1,0] op_sel_hi:[1,1,1]
    v_lshlrev_b32_e64 v24, 16, v40
    v_and_b32 v25, 0xffff0000, v40
    v_pk_fma_f32 v[64:65], v[24:25], v[18:19], v[64:65] op_sel:[0,0,0] op_sel_hi:[1,0,1]
    v_lshlrev_b32_e64 v26, 16, v41
    v_and_b32 v27, 0xffff0000, v41
    v_pk_fma_f32 v[66:67], v[26:27], v[18:19], v[66:67] op_sel:[0,0,0] op_sel_hi:[1,0,1]
    v_lshlrev_b32_e64 v24, 16, v42
    v_and_b32 v25, 0xffff0000, v42
    v_pk_fma_f32 v[68:69], v[24:25], v[18:19], v[68:69] op_sel:[0,0,0] op_sel_hi:[1,0,1]
    v_lshlrev_b32_e64 v26, 16, v43
    v_and_b32 v27, 0xffff0000, v43
    v_pk_fma_f32 v[70:71], v[26:27], v[18:19], v[70:71] op_sel:[0,0,0] op_sel_hi:[1,0,1]
    s_waitcnt vmcnt(3)
    v_lshlrev_b32 v24, 16, v44
    v_and_b32 v25, 0xffff0000, v44
    v_pk_fma_f32 v[64:65], v[24:25], v[18:19], v[64:65] op_sel:[0,1,0] op_sel_hi:[1,1,1]
    v_lshlrev_b32_e64 v26, 16, v45
    v_and_b32 v27, 0xffff0000, v45
    v_pk_fma_f32 v[66:67], v[26:27], v[18:19], v[66:67] op_sel:[0,1,0] op_sel_hi:[1,1,1]
    v_lshlrev_b32_e64 v24, 16, v46
    v_and_b32 v25, 0xffff0000, v46
    v_pk_fma_f32 v[68:69], v[24:25], v[18:19], v[68:69] op_sel:[0,1,0] op_sel_hi:[1,1,1]
    v_lshlrev_b32_e64 v26, 16, v47
    v_and_b32 v27, 0xffff0000, v47
    v_pk_fma_f32 v[70:71], v[26:27], v[18:19], v[70:71] op_sel:[0,1,0] op_sel_hi:[1,1,1]
    s_waitcnt vmcnt(2)
    v_lshlrev_b32 v24, 16, v48
    v_and_b32 v25, 0xffff0000, v48
    v_pk_fma_f32 v[64:65], v[24:25], v[20:21], v[64:65] op_sel:[0,0,0] op_sel_hi:[1,0,1]
    v_lshlrev_b32_e64 v26, 16, v49
K1_stub3:
    s_cbranch_execz K1_back
    s_nop 0
    v_and_b32 v27, 0xffff0000, v49
    v_pk_fma_f32 v[66:67], v[26:27], v[20:21], v[66:67] op_sel:[0,0,0] op_sel_hi:[1,0,1]
    v_lshlrev_b32_e64 v24, 16, v50
    v_and_b32 v25, 0xffff0000, v50
    v_pk_fma_f32 v[68:69], v[24:25], v[20:21], v[68:69] op_sel:[0,0,0] op_sel_hi:[1,0,1]
    v_lshlrev_b32_e64 v26, 16, v51
    v_and_b32 v27, 0xffff0000, v51
    v_pk_fma_f32 v[70:71], v[26:27], v[20:21], v[70:71] op_sel:[0,0,0] op_sel_hi:[1,0,1]
    s_waitcnt vmcnt(1)
    v_lshlrev_b32 v24, 16, v52
    v_and_b32 v25, 0xffff0000, v52
    v_pk_fma_f32 v[64:65], v[24:25], v[20:21], v[64:65] op_sel:[0,1,0] op_sel_hi:[1,1,1]
    v_lshlrev_b32_e64 v26, 16, v53
    v_and_b32 v27, 0xffff0000, v53
    v_pk_fma_f32 v[66:67], v[26:27], v[20:21], v[66:67] op_sel:[0,1,0] op_sel_hi:[1,1,1]
    v_lshlrev_b32_e64 v24, 16, v54
    v_and_b32 v25, 0xffff0000, v54
    v_pk_fma_f32 v[68:69], v[24:25], v[20:21], v[68:69] op_sel:[0,1,0] op_sel_hi:[1,1,1]
    v_lshlrev_b32_e64 v26, 16, v55
    v_and_b32 v27, 0xffff0000, v55
    v_pk_fma_f32 v[70:71], v[26:27], v[20:21], v[70:71] op_sel:[0,1,0] op_sel_hi:[1,1,1]
    s_waitcnt vmcnt(0)
    v_mov_b32 v98, 0
    global_load_dword v99, v98, s[50:51] sc1
    v_lshlrev_b32_e64 v24, 16, v56
    v_and_b32 v25, 0xffff0000, v56
    v_pk_fma_f32 v[64:65], v[24:25], v[22:23], v[64:65] op_sel:[0,0,0] op_sel_hi:[1,0,1]
    v_lshlrev_b32_e64 v26, 16, v57
    v_and_b32 v27, 0xffff0000, v57
    v_pk_fma_f32 v[66:67], v[26:27], v[22:23], v[66:67] op_sel:[0,0,0] op_sel_hi:[1,0,1]
    v_lshlrev_b32_e64 v24, 16, v58
    v_and_b32 v25, 0xffff0000, v58
    v_pk_fma_f32 v[68:69], v[24:25], v[22:23], v[68:69] op_sel:[0,0,0] op_sel_hi:[1,0,1]
    v_lshlrev_b32_e64 v26, 16, v59
    v_and_b32 v27, 0xffff0000, v59
    v_pk_fma_f32 v[70:71], v[26:27], v[22:23], v[70:71] op_sel:[0,0,0] op_sel_hi:[1,0,1]
    v_permlane32_swap_b32 v64, v65
    v_permlane32_swap_b32 v66, v67
    v_permlane32_swap_b32 v68, v69
    v_permlane32_swap_b32 v70, v71
    v_add_f32 v72, v64, v65
    v_add_f32 v73, v66, v67
    v_add_f32 v74, v68, v69
    v_add_f32 v75, v70, v71
    v_permlane16_swap_b32 v72, v73
    s_nop 0
    v_permlane16_swap_b32 v74, v75
    v_add_f32 v72, v72, v73
    v_add_f32 v74, v74, v75
    s_nop 0
    v_add_f32_dpp v72, v72, v72 row_ror:8 row_mask:0xf bank_mask:0xf
    v_add_f32_dpp v74, v74, v74 row_ror:8 row_mask:0xf bank_mask:0xf
    ds_write2_b32 v10, v72, v74 offset0:0 offset1:4
    s_waitcnt lgkmcnt(0)
    s_barrier
    s_cmp_lg_u32 s20, 7
    s_cbranch_scc1 K1_mw
    v_lshlrev_b32_e64 v8, 2, v2
    v_add_u32 v8, 147456, v8
    ds_read2st64_b32 v[16:17], v8 offset0:0 offset1:1
    ds_read2st64_b32 v[18:19], v8 offset0:2 offset1:3
    ds_read2st64_b32 v[20:21], v8 offset0:4 offset1:5
    ds_read2st64_b32 v[22:23], v8 offset0:6 offset1:7
    s_waitcnt lgkmcnt(0)
    v_add_f32 v16, v16, v17
    v_add_f32 v18, v18, v19
    v_add_f32 v20, v20, v21
    v_add_f32 v22, v22, v23
    v_add_f32 v16, v16, v18
    v_add_f32 v20, v20, v22
    v_add_f32 v16, v16, v20
    v_fma_f32 v16, v16, s30, v13
    buffer_store_dword v16, v12, s[16:19], s29 offen sc1
K1_mw:
    s_cmp_lt_u32 s20, 4
    s_cbranch_scc1 AO_m1
    s_add_u32 m0, s61, 0
    s_add_u32 s28, s60, 7168
    buffer_load_dwordx4 v96, s[56:59], s60 offen lds
    s_add_u32 m0, s61, 1024
    s_add_u32 s60, s60, 14336
    buffer_load_dwordx4 v96, s[56:59], s28 offen lds
    s_add_u32 m0, s61, 2048
    s_add_u32 s28, s60, 7168
    buffer_load_dwordx4 v96, s[56:59], s60 offen lds
    s_add_u32 m0, s61, 3072
    s_add_u32 s60, s60, 14336
    buffer_load_dwordx4 v96, s[56:59], s28 offen lds
AO_m1:
    s_branch KS_W0
K1_help:
    s_add_u32 s22, s22, 1
    s_max_u32 s22, s22, 22
    s_sub_u32 s22, s22, 22
    s_mul_i32 s23, s22, 26
    v_min_u32 v5, 25, v2
    v_add_u32 v5, s23, v5
    v_min_u32 v5, 255, v5
    v_mul_u32_u24 v6, 2048, v5
    v_lshrrev_b32 v6, 16, v6
    v_add_u32 v6, 1, v6
    v_mul_u32_u24 v6, 24, v6
    v_add_u32 v5, v5, v6
    v_mul_u32_u24 v6, 5376, v5
    s_lshl_b32 s24, s20, 3
    s_add_u32 s24, s24, s21
    s_lshl_b32 s24, s24, 7
    s_lshl_b32 s27, s22, 3
    s_add_u32 s27, s27, s21
    v_lshlrev_b32_e64 v8, 7, v2
    s_waitcnt lgkmcnt(0)
    s_mov_b32 s12, s46
    s_mov_b32 s13, s47
    s_mov_b32 s14, 2408448
    s_mov_b32 s15, 0x00020000
    s_cmp_ge_u32 s20, 6
    s_cbranch_scc1 K1_h2
    buffer_load_dword v10, v6, s[12:15], s24 offen
    s_branch K1_h3
K1_h2:
    s_cmp_eq_u32 s20, 6
    s_cbranch_scc0 K1_h2b
    s_add_u32 s16, s6, 14680064
    s_addc_u32 s17, s7, 0
    s_mov_b32 s18, 557056
    s_mov_b32 s19, 0x00020000
    s_lshl_b32 s26, s27, 13
    buffer_load_dword v9, v8, s[16:19], s26 offen sc1
    s_add_u32 s16, s6, 1835008
    s_addc_u32 s17, s7, 0
    s_movk_i32 s18, 12288
    s_sub_u32 s26, s26, 491520
    buffer_load_dword v10, v8, s[16:19], s26 offen sc1
    s_branch K1_h3
K1_h2b:
    s_getpc_b64 s[36:37]
K1_pc:
    s_mul_i32 s26, s22, 2560
    v_min_u32 v8, 2432, v8
    v_add_u32 v8, s26, v8
    v_min_u32 v8, code_end-K1_pc-4, v8
    global_load_dword v95, v8, s[36:37]
K1_h3:
    s_waitcnt vmcnt(0)
    v_mov_b32 v98, 0
    global_load_dword v99, v98, s[50:51] sc1
    s_cmp_eq_u32 s20, 7
    s_cbranch_scc1 K1_h5
    s_mul_i32 s23, s22, 18
    s_sub_u32 s24, s22, 6
    s_mul_i32 s24, s24, 29
    s_add_u32 s24, s24, 108
    s_cmp_lt_u32 s22, 6
    s_cselect_b32 s23, s23, s24
    s_cselect_b32 s24, 17, 28
    v_min_u32 v5, s24, v2
    v_add_u32 v5, s23, v5
    v_min_u32 v5, 223, v5
    v_mul_u32_u24 v7, 3584, v5
    s_lshr_b32 s24, s21, 1
    s_mul_i32 s24, s24, 896
    s_lshl_b32 s25, s20, 7
    s_add_u32 s24, s24, s25
    s_and_b32 s25, s21, 1
    s_mul_i32 s25, s25, 802816
    s_add_u32 s26, s24, s25
    s_sub_u32 s25, 802816, s25
    s_add_u32 s25, s24, s25
    s_mov_b32 s12, s8
    s_mov_b32 s13, s9
    s_mov_b32 s14, 1605632
    s_mov_b32 s15, 0x00020000
    s_mov_b32 s16, s10
    s_mov_b32 s17, s11
    s_mov_b32 s18, 1605632
    s_mov_b32 s19, 0x00020000
    buffer_load_dword v95, v7, s[12:15], s26 offen
K1_stub4:
    s_cbranch_execz K1_back
    s_nop 0
    buffer_load_dword v95, v7, s[16:19], s26 offen
    s_cmp_lt_u32 s22, 6
    s_cbranch_scc1 K1_go
    s_sub_u32 s23, s22, 6
    s_mul_i32 s23, s23, 56
    v_min_u32 v5, 55, v2
    v_add_u32 v5, s23, v5
    v_mul_u32_u24 v7, 3584, v5
    s_waitcnt vmcnt(0)
    buffer_load_dword v95, v7, s[12:15], s25 offen
    buffer_load_dword v95, v7, s[16:19], s25 offen
    s_branch K1_go
K1_h5:
    s_cmp_ge_u32 s22, 6
    s_cbranch_scc1 K1_go
    s_mov_b32 s16, s34
    s_mov_b32 s17, s35
    s_mov_b32 s18, 1605632
    s_mov_b32 s19, 0x00020000
    v_min_u32 v7, 43, v2
    v_lshlrev_b32 v7, 7, v7
    s_mul_i32 s26, s27, 16896
    s_add_u32 s26, s26, 802816
    buffer_load_dword v95, v7, s[16:19], s26 offen
    s_add_u32 s25, s26, 5632
    buffer_load_dword v95, v7, s[16:19], s25 offen
    s_add_u32 s25, s25, 5632
    buffer_load_dword v95, v7, s[16:19], s25 offen
    s_sub_u32 s26, s26, 802816
    buffer_load_dword v95, v7, s[16:19], s26 offen
    s_add_u32 s26, s26, 5632
    buffer_load_dword v95, v7, s[16:19], s26 offen
    s_add_u32 s26, s26, 5632
    buffer_load_dword v95, v7, s[16:19], s26 offen
    s_branch K1_go
K1_idle:
    s_waitcnt lgkmcnt(0)
    s_mov_b32 s16, s34
    s_mov_b32 s17, s35
    s_mov_b32 s18, 1605632
    s_mov_b32 s19, 0x00020000
    v_lshlrev_b32 v8, 7, v2
    s_lshl_b32 s26, s20, 13
    buffer_load_dword v95, v8, s[16:19], s26 offen
    s_waitcnt vmcnt(0)
    v_mov_b32 v98, 0
    global_load_dword v99, v98, s[50:51] sc1
K1_go:
    s_lshr_b32 s60, s2, 5
    s_lshl_b32 s60, s60, 7
    s_mul_i32 s61, s20, 200704
    s_add_u32 s60, s60, s61
    s_and_b32 s61, s20, 3
    s_mul_i32 s56, s61, 28672
    s_lshl_b32 s61, s61, 13
    s_add_u32 s61, s61, 114688
    s_cmp_ge_u32 s20, 4
    s_cselect_b32 s61, s56, s61
    v_and_b32 v96, 6, v3
    v_xor_b32 v96, v96, v4
    v_lshlrev_b32 v96, 4, v96
    v_mul_u32_u24 v97, 896, v3
    v_add_u32_e64 v96, v96, v97
    s_mov_b32 s56, s34
    s_mov_b32 s57, s35
    s_mov_b32 s58, 1605632
    s_mov_b32 s59, 0x00020000
    s_cmp_ge_u32 s2, 224
    s_cbranch_scc1 KS_W0
    s_cmp_lt_u32 s20, 4
    s_cbranch_scc1 AO_h1
    s_add_u32 m0, s61, 0
    s_add_u32 s28, s60, 7168
    buffer_load_dwordx4 v96, s[56:59], s60 offen lds
    s_add_u32 m0, s61, 1024
    s_add_u32 s60, s60, 14336
    buffer_load_dwordx4 v96, s[56:59], s28 offen lds
    s_add_u32 m0, s61, 2048
    s_add_u32 s28, s60, 7168
    buffer_load_dwordx4 v96, s[56:59], s60 offen lds
    s_add_u32 m0, s61, 3072
    s_add_u32 s60, s60, 14336
    buffer_load_dwordx4 v96, s[56:59], s28 offen lds
AO_h1:
K1_stub5:
    s_cbranch_execz K1_back
K1_stub6:
    s_cbranch_execz K1_back
K1_end:
KS_W0:
    s_mov_b32 s36, s20
    s_mov_b32 s62, s48
    s_mov_b32 s63, s49
    s_and_b32 s21, s2, 7
    s_lshr_b32 s22, s2, 3
    s_add_u32 s24, s22, 31
    s_and_b32 s24, s24, 31
    s_lshl_b32 s25, s21, 5
    s_add_u32 s25, s25, s24
    s_lshr_b32 s24, s24, 3
    s_lshl_b32 s26, s21, 1
    s_lshr_b32 s27, s24, 1
    s_add_u32 s26, s26, s27
    s_sub_u32 s27, 32, s26
    s_cmp_eq_u32 s26, 0
    s_cselect_b32 s27, 16, s27
    s_bitcmp1_b32 s24, 0
    s_cselect_b32 s23, s27, s26
    s_and_b32 s24, s25, 7
    s_and_b32 s20, s36, 3
    v_and_b32 v6, 15, v2
    v_lshrrev_b32 v7, 4, v2
    v_mov_b32 v5, v96
    v_lshlrev_b32 v15, 4, v2
    s_and_b32 s39, s22, 3
    s_lshr_b32 s42, s22, 2
    s_and_b32 s37, s21, 1
    s_lshl_b32 s37, s37, 2
    s_add_u32 s37, s37, s39
    s_lshr_b32 s38, s21, 1
    s_mul_i32 s38, s38, 7
    s_add_u32 s38, s38, s42
    s_mul_i32 s101, s23, 57344
    s_mul_i32 s3, s20, 14336
    s_add_u32 s101, s101, s3
    s_lshl_b32 s3, s20, 11
    s_add_u32 s3, s3, 80896
    s_mul_i32 s28, s20, 43
    v_min_u32 v13, 42, v2
    v_add_u32_e64 v13, s28, v13
    v_min_u32 v13, 169, v13
    v_lshlrev_b32_e64 v13, 7, v13
    s_add_u32 s16, s6, 15073280
    s_addc_u32 s17, s7, 0
    s_mov_b32 s18, 32768
    s_mov_b32 s19, 0x00020000
    s_mov_b32 s12, s6
    s_mov_b32 s13, s7
    s_mov_b32 s14, 1847296
    s_mov_b32 s15, 0x00020000
    s_cmp_lt_u32 s36, 4
    s_cbranch_scc1 KB_A
    v_cvt_f32_u32 v136, v6
    v_mul_f32 v136, 0x3c800000, v136
    v_lshlrev_b32 v137, 4, v7
    v_xor_b32 v135, 16, v137
    v_cvt_f32_u32 v137, v137
    v_cvt_f32_u32 v135, v135
    v_mul_f32 v137, v137, v136
    v_mul_f32 v135, v135, v136
    v_mov_b32 v138, v137
    v_cos_f32 v139, v138
    v_sin_f32 v140, v138
    s_nop 0
    v_cvt_pk_bf16_f32 v16, v139, v140
    v_fmamk_f32 v141, v136, 0x40800000, v137
    v_cos_f32 v142, v141
    v_sin_f32_e64 v143, v141
    s_nop 0
    v_cvt_pk_bf16_f32 v17, v142, v143
    v_fmamk_f32 v138, v136, 0x41000000, v137
    v_cos_f32 v139, v138
    v_sin_f32_e64 v140, v138
    s_nop 0
    v_cvt_pk_bf16_f32 v18, v139, v140
    v_fmamk_f32 v141, v136, 0x41400000, v137
    v_cos_f32 v142, v141
    v_sin_f32_e64 v143, v141
    s_nop 0
    v_cvt_pk_bf16_f32 v19, v142, v143
    v_fmamk_f32 v138, v136, 0x3f800000, v137
    v_cos_f32 v139, v138
    v_sin_f32_e64 v140, v138
    s_nop 0
    v_cvt_pk_bf16_f32 v24, v139, v140
    v_cvt_pk_bf16_f32 v32, -v140, v139
    v_fmamk_f32 v141, v136, 0x40a00000, v137
    v_cos_f32 v142, v141
    v_sin_f32_e64 v143, v141
    s_nop 0
    v_cvt_pk_bf16_f32 v25, v142, v143
    v_cvt_pk_bf16_f32 v33, -v143, v142
    v_fmamk_f32 v138, v136, 0x41100000, v137
    v_cos_f32 v139, v138
    v_sin_f32_e64 v140, v138
    s_nop 0
    v_cvt_pk_bf16_f32 v26, v139, v140
    v_cvt_pk_bf16_f32 v34, -v140, v139
    v_fmamk_f32 v141, v136, 0x41500000, v137
    v_cos_f32 v142, v141
    v_sin_f32_e64 v143, v141
    s_nop 0
    v_cvt_pk_bf16_f32 v27, v142, v143
    v_cvt_pk_bf16_f32 v35, -v143, v142
    v_fmamk_f32 v138, v136, 0x40000000, v135
    v_cos_f32 v139, v138
    v_sin_f32_e64 v140, v138
    s_nop 0
    v_cvt_pk_bf16_f32 v20, v139, v140
    v_fmamk_f32 v141, v136, 0x40c00000, v135
    v_cos_f32 v142, v141
    v_sin_f32_e64 v143, v141
    s_nop 0
    v_cvt_pk_bf16_f32 v21, v142, v143
    v_fmamk_f32 v138, v136, 0x41200000, v135
    v_cos_f32 v139, v138
    v_sin_f32_e64 v140, v138
    s_nop 0
    v_cvt_pk_bf16_f32 v22, v139, v140
    v_fmamk_f32 v141, v136, 0x41600000, v135
    v_cos_f32 v142, v141
    v_sin_f32_e64 v143, v141
    s_nop 0
    v_cvt_pk_bf16_f32 v23, v142, v143
    v_fmamk_f32 v138, v136, 0x40400000, v135
    v_cos_f32 v139, v138
    v_sin_f32_e64 v140, v138
    s_nop 0
    v_cvt_pk_bf16_f32 v28, v139, v140
    v_cvt_pk_bf16_f32 v36, v140, -v139
    v_fmamk_f32 v141, v136, 0x40e00000, v135
    v_cos_f32 v142, v141
    v_sin_f32_e64 v143, v141
    s_nop 0
    v_cvt_pk_bf16_f32 v29, v142, v143
    v_cvt_pk_bf16_f32 v37, v143, -v142
    v_fmamk_f32 v138, v136, 0x41300000, v135
    v_cos_f32 v139, v138
    v_sin_f32_e64 v140, v138
    s_nop 0
    v_cvt_pk_bf16_f32 v30, v139, v140
    v_cvt_pk_bf16_f32 v38, v140, -v139
    v_fmamk_f32 v141, v136, 0x41700000, v135
    v_cos_f32 v142, v141
    v_sin_f32_e64 v143, v141
    s_nop 0
    v_cvt_pk_bf16_f32 v31, v142, v143
    v_cvt_pk_bf16_f32 v39, v143, -v142
    s_sub_u32 s28, s2, 8
    s_cmp_ge_u32 s28, 170
    s_cbranch_scc1 KS_nopubb
    s_waitcnt vmcnt(4)
    s_barrier
    s_mov_b32 s33, 0
NL_db:
    v_readfirstlane_b32 s100, v99
    s_add_u32 s33, s33, 1
    s_cmp_lg_u32 s100, 0
    s_cbranch_scc1 ND_db
    global_load_dword v99, v98, s[50:51] sc1
    s_cmp_lt_u32 s33, 200000
    s_waitcnt vmcnt(0)
    s_cbranch_scc1 NL_db
ND_db:
KS_nopubb:
    s_mov_b32 s52, s4
    s_mov_b32 s53, s5
    s_mov_b32 s54, 1835008
    s_mov_b32 s55, 0x00020000
    s_sub_u32 s40, 64, s23
    s_cmp_eq_u32 s23, 0
    s_cselect_b32 s40, 32, s40
    s_cmp_lt_u32 s20, 2
    s_cselect_b32 s40, s23, s40
    s_and_b32 s41, s20, 1
    s_lshl_b32 s41, s41, 1
    s_lshl_b32 s29, s24, 2
    s_add_u32 s41, s41, s29
    s_lshl_b32 s41, s41, 6
    s_add_u32 s40, s40, s41
    s_mul_i32 s40, s40, 896
    s_add_u32 m0, s61, 26624
    s_add_u32 s41, s40, 57344
    buffer_load_dwordx4 v15, s[52:55], s40 offen lds
    s_add_u32 m0, s61, 27648
    s_cmp_ge_u32 s22, 28
    buffer_load_dwordx4 v15, s[52:55], s41 offen lds
    s_cbranch_scc1 KB_Bw00
    s_add_u32 m0, s61, 4096
    s_add_u32 s28, s60, 7168
    buffer_load_dwordx4 v5, s[56:59], s60 offen lds
    s_add_u32 m0, s61, 5120
    s_add_u32 s60, s60, 14336
    buffer_load_dwordx4 v5, s[56:59], s28 offen lds
    s_add_u32 m0, s61, 6144
    s_add_u32 s28, s60, 7168
    buffer_load_dwordx4 v5, s[56:59], s60 offen lds
    s_add_u32 m0, s61, 7168
    s_add_u32 s60, s60, 14336
    buffer_load_dwordx4 v5, s[56:59], s28 offen lds
    s_add_u32 m0, s61, 8192
    s_add_u32 s28, s60, 7168
    buffer_load_dwordx4 v5, s[56:59], s60 offen lds
    s_add_u32 m0, s61, 9216
    s_add_u32 s60, s60, 14336
    buffer_load_dwordx4 v5, s[56:59], s28 offen lds
    s_add_u32 m0, s61, 10240
    s_add_u32 s28, s60, 7168
    buffer_load_dwordx4 v5, s[56:59], s60 offen lds
    s_add_u32 m0, s61, 11264
    s_add_u32 s60, s60, 14336
    buffer_load_dwordx4 v5, s[56:59], s28 offen lds
    s_add_u32 m0, s61, 12288
    s_add_u32 s28, s60, 7168
    buffer_load_dwordx4 v5, s[56:59], s60 offen lds
    s_add_u32 m0, s61, 13312
    s_add_u32 s60, s60, 14336
    buffer_load_dwordx4 v5, s[56:59], s28 offen lds
    s_add_u32 m0, s61, 14336
    s_add_u32 s28, s60, 7168
    buffer_load_dwordx4 v5, s[56:59], s60 offen lds
    s_add_u32 m0, s61, 15360
    s_add_u32 s60, s60, 14336
    buffer_load_dwordx4 v5, s[56:59], s28 offen lds
KB_Bw00:
    v_and_b32 v11, 1, v7
    v_mul_u32_u24 v12, 7, v6
    v_lshl_add_u32 v12, v11, 2, v12
    v_lshrrev_b32 v9, 1, v7
    v_lshlrev_b32 v40, 10, v9
    v_lshl_add_u32 v40, v12, 1, v40
    s_add_u32 s31, s61, 26624
    v_add_u32 v40, s31, v40
    v_lshrrev_b32 v132, 2, v6
    v_lshl_add_u32 v132, v7, 2, v132
    v_bfe_u32 v133, v132, 1, 2
    v_lshlrev_b32 v132, 7, v132
    v_and_b32 v134, 3, v6
    v_lshl_add_u32 v132, v134, 3, v132
    v_xor_b32_e64 v134, 0, v133
    v_lshl_add_u32 v134, v134, 5, v132
    v_add_u32 v136, s61, v134
    v_xor_b32 v134, 1, v133
    v_lshl_add_u32 v134, v134, 5, v132
    v_add_u32 v137, s61, v134
    v_xor_b32 v134, 2, v133
    v_lshl_add_u32 v134, v134, 5, v132
    v_add_u32 v138, s61, v134
    v_xor_b32 v134, 3, v133
    v_lshl_add_u32 v134, v134, 5, v132
    v_add_u32_e64 v139, s61, v134
    s_lshl_b32 s43, s24, 2
    s_add_u32 s43, s43, s20
    s_mul_i32 s43, s43, 1792
    s_mul_i32 s28, s23, 57344
    s_add_u32 s43, s43, s28
    v_min_u32 v62, 13, v2
    v_lshlrev_b32 v62, 7, v62
    s_cmp_ge_u32 s22, 28
    s_cbranch_scc1 KB_Bx0
    s_waitcnt vmcnt(12)
    s_branch KB_Bx1
KB_Bx0:
    s_waitcnt vmcnt(0)
KB_Bx1:
    ds_read_u16 v64, v40 offset:0
    ds_read_u16 v65, v40 offset:2
    ds_read_u16 v66, v40 offset:4
    ds_read_u16 v67, v40 offset:6
    ds_read_u16 v68, v40 offset:224
    ds_read_u16 v69, v40 offset:226
    ds_read_u16 v70, v40 offset:228
    ds_read_u16 v71, v40 offset:230
    ds_read_u16 v72, v40 offset:448
    ds_read_u16 v73, v40 offset:450
    ds_read_u16 v74, v40 offset:452
    ds_read_u16 v75, v40 offset:454
    ds_read_u16 v76, v40 offset:672
    ds_read_u16 v77, v40 offset:674
    ds_read_u16 v78, v40 offset:676
    ds_read_u16 v79, v40 offset:678
    v_bfe_u32 v14, v3, 1, 1
    v_xor_b32_e64 v14, v14, v4
    v_mul_u32_u24 v59, 3584, v3
    v_lshl_add_u32 v14, v14, 4, v59
    v_xor_b32 v1, 64, v14
    v_lshlrev_b32 v41, 4, v6
    v_lshl_add_u32 v41, v11, 8, v41
    v_add_u32 v41, 140288, v41
    s_mul_i32 s29, s20, 4352
    s_add_u32 s29, s29, 146432
    v_mul_u32_u24 v9, 1808, v9
    v_lshl_add_u32 v9, v12, 2, v9
    v_add_u32_e64 v9, s29, v9
    v_add_u32 v10, 896, v9
    v_and_b32 v59, 7, v6
    v_min_u32 v59, 6, v59
    v_lshrrev_b32_e64 v12, 3, v6
    v_lshl_add_u32 v59, v59, 1, v12
    v_mul_u32_u24 v12, 272, v59
    v_lshl_add_u32 v12, v7, 4, v12
    v_add_u32 v12, s29, v12
    v_add_u32 v11, -1, v11
    s_lshl_b32 s29, s20, 3
    v_add_u32 v59, s29, v3
    v_lshrrev_b32_e64 v42, 1, v4
    v_mul_u32_u24 v42, 4352, v42
    v_and_b32_e64 v43, 1, v4
    v_mul_u32_u24 v43, 1808, v43
    v_add_u32_e64 v42, v42, v43
    v_lshl_add_u32 v42, v59, 5, v42
    v_add_u32 v42, 146432, v42
    v_lshlrev_b32_e64 v43, 9, v59
    v_lshl_add_u32 v43, v4, 4, v43
    s_lshl_b32 s32, s20, 2
    s_add_u32 s32, s32, 139424
    v_mov_b32 v60, s32
    v_and_b32 v61, 3, v2
    v_lshlrev_b32 v61, 2, v61
    v_add_u32 v61, 139424, v61
    s_lshr_b32 s40, s25, 2
    s_mul_i32 s40, s40, 28672
    s_and_b32 s41, s25, 3
    s_lshl_b32 s41, s41, 7
    s_add_u32 s40, s40, s41
    s_add_u32 s41, s40, 16384
    s_waitcnt lgkmcnt(0)
    v_and_b32 v67, v67, v11
    v_and_b32 v71, v71, v11
    v_and_b32 v75, v75, v11
    v_and_b32 v79, v79, v11
    v_lshlrev_b32 v64, 16, v64
    v_lshlrev_b32 v65, 16, v65
    v_lshlrev_b32 v66, 16, v66
    v_lshlrev_b32 v67, 16, v67
    v_lshlrev_b32 v68, 16, v68
    v_lshlrev_b32 v69, 16, v69
    v_lshlrev_b32 v70, 16, v70
    v_lshlrev_b32 v71, 16, v71
    v_lshlrev_b32 v72, 16, v72
    v_lshlrev_b32 v73, 16, v73
    v_lshlrev_b32 v74, 16, v74
    v_lshlrev_b32 v75, 16, v75
    v_lshlrev_b32 v76, 16, v76
    v_lshlrev_b32 v77, 16, v77
    v_lshlrev_b32 v78, 16, v78
    v_lshlrev_b32_e64 v79, 16, v79
    s_cmp_ge_u32 s22, 28
    s_cbranch_scc1 KB_Bw0
    ds_read_b64_tr_b16 a[0:1], v136 offset:0
    ds_read_b64_tr_b16 a[4:5], v137 offset:0
    ds_read_b64_tr_b16 a[8:9], v138 offset:0
    ds_read_b64_tr_b16 a[12:13], v139 offset:0
    ds_read_b64_tr_b16 a[2:3], v136 offset:2048
    ds_read_b64_tr_b16 a[6:7], v137 offset:2048
    ds_read_b64_tr_b16 a[10:11], v138 offset:2048
    ds_read_b64_tr_b16 a[14:15], v139 offset:2048
    s_waitcnt vmcnt(10)
    ds_read_b64_tr_b16 a[16:17], v136 offset:4096
    ds_read_b64_tr_b16 a[20:21], v137 offset:4096
    ds_read_b64_tr_b16 a[24:25], v138 offset:4096
    ds_read_b64_tr_b16 a[28:29], v139 offset:4096
    s_waitcnt vmcnt(8)
    ds_read_b64_tr_b16 a[18:19], v136 offset:6144
    ds_read_b64_tr_b16 a[22:23], v137 offset:6144
    ds_read_b64_tr_b16 a[26:27], v138 offset:6144
    ds_read_b64_tr_b16 a[30:31], v139 offset:6144
    s_waitcnt vmcnt(6)
    buffer_load_dword v8, v13, s[16:19], 0 offen sc1
    ds_read_b64_tr_b16 a[32:33], v136 offset:8192
    ds_read_b64_tr_b16 a[36:37], v137 offset:8192
    ds_read_b64_tr_b16 a[40:41], v138 offset:8192
    ds_read_b64_tr_b16 a[44:45], v139 offset:8192
    s_waitcnt vmcnt(5)
    ds_read_b64_tr_b16 a[34:35], v136 offset:10240
    ds_read_b64_tr_b16 a[38:39], v137 offset:10240
    ds_read_b64_tr_b16 a[42:43], v138 offset:10240
    ds_read_b64_tr_b16 a[46:47], v139 offset:10240
    s_waitcnt vmcnt(3)
    ds_read_b64_tr_b16 a[48:49], v136 offset:12288
    ds_read_b64_tr_b16 a[52:53], v137 offset:12288
    ds_read_b64_tr_b16 a[56:57], v138 offset:12288
    ds_read_b64_tr_b16 a[60:61], v139 offset:12288
    s_waitcnt vmcnt(1)
    ds_read_b64_tr_b16 a[50:51], v136 offset:14336
    ds_read_b64_tr_b16 a[54:55], v137 offset:14336
    ds_read_b64_tr_b16 a[58:59], v138 offset:14336
    ds_read_b64_tr_b16 a[62:63], v139 offset:14336
    s_branch KB_Bw1
KB_Bw0:
    buffer_load_dword v8, v13, s[16:19], 0 offen sc1
KB_Bw1:
    s_sub_u32 s28, s2, 8
    s_cmp_lt_u32 s28, 170
    s_cbranch_scc1 KS_hnb
    s_waitcnt vmcnt(0)
    s_mov_b32 s33, 0
NL_lb:
    v_readfirstlane_b32 s100, v99
    s_add_u32 s33, s33, 1
    s_cmp_lg_u32 s100, 0
    s_cbranch_scc1 ND_lb
    global_load_dword v99, v98, s[50:51] sc1
    s_cmp_lt_u32 s33, 200000
    s_waitcnt vmcnt(0)
    s_cbranch_scc1 NL_lb
ND_lb:
KS_hnb:
    s_waitcnt vmcnt(0)
    s_mov_b32 s33, 0
    s_branch PC_ub
PL_ub:
    buffer_load_dword v8, v13, s[16:19], 0 offen sc1
    s_add_u32 s33, s33, 1
    s_waitcnt vmcnt(0)
PC_ub:
    v_cmp_ne_u32 vcc, s100, v8
    s_nop 0
    s_cbranch_vccz PD_ub
    s_mov_b64 exec, vcc
    s_cmp_lt_u32 s33, 200000
    s_cbranch_scc1 PL_ub
PD_ub:
    s_mov_b64 exec, -1
    s_waitcnt lgkmcnt(0)
    s_barrier
    s_add_u32 m0, s3, 16384
    s_add_u32 s28, s101, 256
    buffer_load_dwordx4 v5, s[12:15], s28 offen sc1 lds
    s_add_u32 m0, s3, 17408
    s_add_u32 s28, s101, 7424
    buffer_load_dwordx4 v5, s[12:15], s28 offen sc1 lds
    s_add_u32 m0, s3, 40960
    s_add_u32 s28, s101, 640
    buffer_load_dwordx4 v5, s[12:15], s28 offen sc1 lds
    s_add_u32 m0, s3, 41984
    s_add_u32 s28, s101, 7808
    buffer_load_dwordx4 v5, s[12:15], s28 offen sc1 lds
    s_add_u32 m0, s3, 24576
    s_add_u32 s28, s101, 384
    buffer_load_dwordx4 v5, s[12:15], s28 offen sc1 lds
    s_add_u32 m0, s3, 25600
    s_add_u32 s28, s101, 7552
    buffer_load_dwordx4 v5, s[12:15], s28 offen sc1 lds
    s_add_u32 m0, s3, 32768
    s_add_u32 s28, s101, 512
    buffer_load_dwordx4 v5, s[12:15], s28 offen sc1 lds
    s_add_u32 m0, s3, 33792
    s_add_u32 s28, s101, 7680
    buffer_load_dwordx4 v5, s[12:15], s28 offen sc1 lds
    s_lshl_b32 s29, s20, 11
    s_max_u32 s30, s29, 2048
    s_add_u32 m0, s30, 138240
    s_add_u32 s31, s30, 1835008
    s_barrier
    buffer_load_dwordx4 v15, s[12:15], s31 offen sc1 lds
    buffer_load_dwordx4 v15, s[12:15], s31 offen offset:1024 sc1 lds
    s_mov_b32 s44, s8
    s_mov_b32 s45, s9
    s_mov_b32 s46, 1605632
    s_mov_b32 s47, 0x00020000
    s_mov_b32 s48, s10
    s_mov_b32 s49, s11
    s_mov_b32 s50, 1605632
    s_mov_b32 s51, 0x00020000
    s_add_u32 s28, s20, 0
    s_mul_i32 s26, s28, 28672
    s_lshl_b32 s32, s38, 7
    s_add_u32 s26, s26, s32
    s_lshl_b32 s27, s28, 11
    s_waitcnt vmcnt(6)
    s_barrier
    s_add_u32 s12, s6, 2097152
    s_addc_u32 s13, s7, 0
    s_mov_b32 s14, 1835008
    s_mov_b32 s15, 0x00020000
    s_add_u32 s16, s6, 4194304
    s_addc_u32 s17, s7, 0
    s_mov_b32 s18, 1835008
    s_mov_b32 s19, 0x00020000
    s_add_u32 s52, s6, 14680064
    s_addc_u32 s53, s7, 0
    s_mov_b32 s54, 557056
    s_mov_b32 s55, 0x00020000
    s_lshl_b32 s29, s25, 2
    s_add_u32 s29, s29, s20
    s_lshl_b32 s29, s29, 7
    s_mov_b32 s30, 0x05040100
    s_mov_b32 s31, 0x07060302
    s_waitcnt vmcnt(2)
    s_barrier
    s_cmp_ge_u32 s22, 28
    s_cbranch_scc1 KB_Bnow3
    s_add_u32 m0, s27, 0
    s_add_u32 s28, s26, 0
    buffer_load_dwordx4 v14, s[44:47], s28 offen lds
    s_add_u32 m0, s27, 1024
    s_add_u32 s28, s26, 0
    s_nop 0
    buffer_load_dwordx4 v1, s[48:51], s28 offen lds
    s_add_u32 m0, s27, 8192
    s_add_u32 s28, s26, 114688
    buffer_load_dwordx4 v14, s[44:47], s28 offen lds
    s_add_u32 m0, s27, 9216
    s_add_u32 s28, s26, 114688
    buffer_load_dwordx4 v1, s[48:51], s28 offen lds
    s_add_u32 m0, s27, 16384
    s_add_u32 s28, s26, 229376
    buffer_load_dwordx4 v14, s[44:47], s28 offen lds
    s_add_u32 m0, s27, 17408
    s_add_u32 s28, s26, 229376
    buffer_load_dwordx4 v1, s[48:51], s28 offen lds
    s_waitcnt vmcnt(6)
    s_branch KB_Bw3
KB_Bnow3:
    s_waitcnt vmcnt(0)
KB_Bw3:
    s_setprio 3
    s_barrier
    ds_read_b128 v[48:51], v12 offset:64
    ds_read_b128 v[56:59], v12 offset:192
    ds_read_b128 v[44:47], v12 offset:0
    ds_read_b128 v[52:55], v12 offset:128
    ds_read_b128 v[80:83], v41 offset:0
    ds_read_b128 v[84:87], v41 offset:512
    ds_read_b128 v[88:91], v41 offset:1024
    ds_read_b128 v[92:95], v41 offset:1536
    s_waitcnt lgkmcnt(7)
    v_mfma_f32_16x16x32_bf16 v[136:139], v[48:51], v[24:27], 0
    v_mfma_f32_16x16x32_bf16 v[140:143], v[48:51], v[32:35], 0
    s_waitcnt lgkmcnt(4)
    s_nop 0
    v_mfma_f32_16x16x32_bf16 v[136:139], v[56:59], v[28:31], v[136:139]
    ds_read_b128 v[96:99], v41 offset:2048
    v_mfma_f32_16x16x32_bf16 v[140:143], v[56:59], v[36:39], v[140:143]
    ds_read_b128 v[100:103], v41 offset:2560
    v_mfma_f32_16x16x32_bf16 v[128:131], v[44:47], v[16:19], 0
    ds_read_b128 v[104:107], v41 offset:3072
    v_mfma_f32_16x16x32_bf16 v[132:135], v[52:55], v[20:23], 0
    ds_read_b128 v[108:111], v41 offset:3584
    ds_read_b128 v[112:115], v41 offset:4096
    ds_read_b128 v[116:119], v41 offset:4608
    ds_read_b128 v[120:123], v41 offset:5120
    ds_read_b128 v[124:127], v41 offset:5632
    s_waitcnt lgkmcnt(8)
    v_and_b32 v83, v83, v11
    v_and_b32 v87, v87, v11
    v_and_b32 v91, v91, v11
    v_and_b32_e64 v95, v95, v11
    v_pk_add_f32 v[24:25], v[128:129], v[132:133]
    v_pk_add_f32 v[28:29], v[128:129], v[132:133] neg_lo:[0,1] neg_hi:[0,1]
    v_pk_add_f32 v[26:27], v[130:131], v[134:135]
    v_pk_add_f32 v[30:31], v[130:131], v[134:135] neg_lo:[0,1] neg_hi:[0,1]
    v_pk_add_f32 v[32:33], v[24:25], v[136:137]
    v_pk_fma_f32 v[64:65], v[32:33], v[80:81], v[64:65]
    v_pk_mul_f32 v[18:19], v[64:65], v[64:65]
    v_pk_add_f32 v[34:35], v[26:27], v[138:139]
    v_pk_fma_f32 v[66:67], v[34:35], v[82:83], v[66:67]
    v_pk_add_f32 v[16:17], v[64:65], v[66:67]
    v_pk_fma_f32 v[18:19], v[66:67], v[66:67], v[18:19]
    v_pk_add_f32 v[32:33], v[28:29], v[140:141]
    v_pk_fma_f32 v[68:69], v[32:33], v[84:85], v[68:69]
    v_pk_add_f32 v[16:17], v[16:17], v[68:69]
    v_pk_fma_f32 v[18:19], v[68:69], v[68:69], v[18:19]
    v_pk_add_f32 v[34:35], v[30:31], v[142:143]
    v_pk_fma_f32 v[70:71], v[34:35], v[86:87], v[70:71]
    v_pk_add_f32 v[16:17], v[16:17], v[70:71]
    v_pk_fma_f32 v[18:19], v[70:71], v[70:71], v[18:19]
    v_pk_add_f32 v[32:33], v[24:25], v[136:137] neg_lo:[0,1] neg_hi:[0,1]
    v_pk_fma_f32 v[72:73], v[32:33], v[88:89], v[72:73]
    v_pk_add_f32 v[16:17], v[16:17], v[72:73]
    v_pk_fma_f32 v[18:19], v[72:73], v[72:73], v[18:19]
    v_pk_add_f32 v[34:35], v[26:27], v[138:139] neg_lo:[0,1] neg_hi:[0,1]
    v_pk_fma_f32 v[74:75], v[34:35], v[90:91], v[74:75]
    v_pk_add_f32 v[16:17], v[16:17], v[74:75]
    v_pk_fma_f32 v[18:19], v[74:75], v[74:75], v[18:19]
    v_pk_add_f32 v[32:33], v[28:29], v[140:141] neg_lo:[0,1] neg_hi:[0,1]
    v_pk_fma_f32 v[76:77], v[32:33], v[92:93], v[76:77]
    v_pk_add_f32 v[16:17], v[16:17], v[76:77]
    v_pk_fma_f32 v[18:19], v[76:77], v[76:77], v[18:19]
    v_pk_add_f32 v[34:35], v[30:31], v[142:143] neg_lo:[0,1] neg_hi:[0,1]
    v_pk_fma_f32 v[78:79], v[34:35], v[94:95], v[78:79]
    v_pk_add_f32 v[16:17], v[16:17], v[78:79]
    v_pk_fma_f32 v[18:19], v[78:79], v[78:79], v[18:19]
    v_add_f32 v16, v16, v17
    v_add_f32 v18, v18, v19
    s_nop 1
    v_permlane16_swap_b32 v16, v18
    v_add_f32 v16, v16, v18
    s_nop 1
    v_add_f32_dpp v16, v16, v16 quad_perm:[1,0,3,2] row_mask:0xf bank_mask:0xf
    s_nop 1
    v_add_f32_dpp v16, v16, v16 quad_perm:[2,3,0,1] row_mask:0xf bank_mask:0xf
    s_nop 1
    v_add_f32_dpp v16, v16, v16 row_half_mirror row_mask:0xf bank_mask:0xf
    s_nop 1
    v_add_f32_dpp v16, v16, v16 row_mirror row_mask:0xf bank_mask:0xf
    v_mov_b32 v18, v16
    v_mov_b32 v19, 0x3727c5ac
    s_nop 0
    v_permlane16_swap_b32 v16, v18
    v_mul_f32 v16, 0x3b124925, v16
    v_fmamk_f32 v18, v18, 0x3b124925, v19
    v_fma_f32 v18, -v16, v16, v18
    v_max_f32 v18, v18, v19
    v_rsq_f32 v17, v18
    s_waitcnt lgkmcnt(0)
    v_mul_f32 v16, v16, v17
    v_pk_fma_f32 v[130:131], v[66:67], v[16:17], v[16:17] op_sel:[0,1,0] op_sel_hi:[1,1,0] neg_lo:[0,0,1] neg_hi:[0,0,1]
    v_pk_fma_f32 v[130:131], v[130:131], v[98:99], v[114:115]
    v_cvt_pk_bf16_f32 v22, v130, v66
    v_cvt_pk_bf16_f32 v23, v131, v67
    ds_write2_b32 v9, v22, v23 offset0:2 offset1:3
    v_pk_fma_f32 v[134:135], v[70:71], v[16:17], v[16:17] op_sel:[0,1,0] op_sel_hi:[1,1,0] neg_lo:[0,0,1] neg_hi:[0,0,1]
    v_pk_fma_f32 v[134:135], v[134:135], v[102:103], v[118:119]
    v_cvt_pk_bf16_f32 v26, v134, v70
    v_cvt_pk_bf16_f32 v27, v135, v71
    ds_write2_b32 v9, v26, v27 offset0:114 offset1:115
    v_pk_fma_f32 v[138:139], v[74:75], v[16:17], v[16:17] op_sel:[0,1,0] op_sel_hi:[1,1,0] neg_lo:[0,0,1] neg_hi:[0,0,1]
    v_pk_fma_f32 v[138:139], v[138:139], v[106:107], v[122:123]
    v_cvt_pk_bf16_f32 v30, v138, v74
    v_cvt_pk_bf16_f32 v31, v139, v75
    ds_write2_b32 v10, v30, v31 offset0:2 offset1:3
    v_pk_fma_f32 v[142:143], v[78:79], v[16:17], v[16:17] op_sel:[0,1,0] op_sel_hi:[1,1,0] neg_lo:[0,0,1] neg_hi:[0,0,1]
    v_pk_fma_f32 v[142:143], v[142:143], v[110:111], v[126:127]
    v_cvt_pk_bf16_f32 v34, v142, v78
    v_cvt_pk_bf16_f32 v35, v143, v79
    ds_write2_b32 v10, v34, v35 offset0:114 offset1:115
    v_pk_fma_f32 v[128:129], v[64:65], v[16:17], v[16:17] op_sel:[0,1,0] op_sel_hi:[1,1,0] neg_lo:[0,0,1] neg_hi:[0,0,1]
    v_pk_fma_f32 v[128:129], v[128:129], v[96:97], v[112:113]
    v_cvt_pk_bf16_f32 v20, v128, v64
    v_cvt_pk_bf16_f32 v21, v129, v65
    ds_write2_b32 v9, v20, v21 offset0:0 offset1:1
    v_pk_fma_f32 v[132:133], v[68:69], v[16:17], v[16:17] op_sel:[0,1,0] op_sel_hi:[1,1,0] neg_lo:[0,0,1] neg_hi:[0,0,1]
    v_pk_fma_f32 v[132:133], v[132:133], v[100:101], v[116:117]
    v_cvt_pk_bf16_f32 v24, v132, v68
    v_cvt_pk_bf16_f32 v25, v133, v69
    ds_write2_b32 v9, v24, v25 offset0:112 offset1:113
    v_pk_fma_f32 v[136:137], v[72:73], v[16:17], v[16:17] op_sel:[0,1,0] op_sel_hi:[1,1,0] neg_lo:[0,0,1] neg_hi:[0,0,1]
    v_pk_fma_f32 v[136:137], v[136:137], v[104:105], v[120:121]
    v_cvt_pk_bf16_f32 v28, v136, v72
    v_cvt_pk_bf16_f32 v29, v137, v73
    ds_write2_b32 v10, v28, v29 offset0:0 offset1:1
    v_pk_fma_f32 v[140:141], v[76:77], v[16:17], v[16:17] op_sel:[0,1,0] op_sel_hi:[1,1,0] neg_lo:[0,0,1] neg_hi:[0,0,1]
    v_pk_fma_f32 v[140:141], v[140:141], v[108:109], v[124:125]
    v_cvt_pk_bf16_f32 v32, v140, v76
    v_cvt_pk_bf16_f32 v33, v141, v77
    ds_write2_b32 v10, v32, v33 offset0:112 offset1:113
    ds_write_b32 v60, v60
    v_mov_b32 v16, s100
    v_mov_b32 v17, s100
    v_mov_b32 v18, s100
    v_mov_b32_e64 v19, s100
    s_mov_b32 s33, 0
KW_ol:
    ds_read_b32 v38, v61 offset:0
    s_add_u32 s33, s33, 1
    s_waitcnt lgkmcnt(0)
    v_cmp_eq_u32_e64 vcc, 0, v38
    s_nop 0
    s_cbranch_vccz KWD_ol
    s_cmp_lt_u32 s33, 800000
    s_cbranch_scc1 KW_ol
KWD_ol:
    ds_read_b128 v[80:83], v42
    ds_read_b128 v[84:87], v42 offset:16
    s_cmp_eq_u32 s20, 3
    s_cbranch_scc1 KB_B3
    ds_read_b128 v[88:91], v42 offset:1024
    ds_read_b128 v[92:95], v42 offset:1040
    s_waitcnt lgkmcnt(0)
    v_perm_b32 v104, v89, v88, s30
    v_perm_b32 v105, v91, v90, s30
    v_perm_b32 v106, v93, v92, s30
    v_perm_b32 v107, v95, v94, s30
    buffer_store_dwordx4 v[104:107], v43, s[12:15], s41 offen sc1
KB_B3:
    s_waitcnt lgkmcnt(0)
    s_nop 0
    v_perm_b32 v96, v81, v80, s30
    v_perm_b32 v97, v83, v82, s30
    v_perm_b32 v98, v85, v84, s30
    v_perm_b32 v99, v87, v86, s30
    buffer_store_dwordx4 v[96:99], v43, s[12:15], s40 offen sc1
    v_perm_b32 v100, v81, v80, s31
    v_perm_b32 v101, v83, v82, s31
    v_perm_b32 v102, v85, v84, s31
    v_perm_b32 v103, v87, v86, s31
    v_perm_b32 v108, v89, v88, s31
    v_perm_b32 v109, v91, v90, s31
    v_perm_b32 v110, v93, v92, s31
    v_perm_b32 v111, v95, v94, s31
    s_waitcnt vmcnt(0)
    s_mov_b64 exec, 0xff
    buffer_store_dwordx4 v[16:19], v15, s[52:55], s29 offen sc1
    s_mov_b64 exec, -1
    ds_write_b32 v60, v60 offset:16
    s_setprio 0
    buffer_store_dwordx4 v[100:103], v43, s[16:19], s40 offen sc1
    s_cmp_eq_u32 s20, 3
    s_cbranch_scc1 KB_B4
    buffer_store_dwordx4 v[108:111], v43, s[16:19], s41 offen sc1
KB_B4:
    s_add_u32 s29, s29, 425984
    s_waitcnt vmcnt(0)
    s_mov_b64 exec, 0xff
    buffer_store_dwordx4 v[16:19], v15, s[52:55], s29 offen sc1
    s_mov_b64 exec, -1
    s_cmp_ge_u32 s22, 28
    s_cbranch_scc1 KB_Bw3b
    s_waitcnt vmcnt(0)
KB_Bw3b:
    s_barrier
    s_cmp_ge_u32 s22, 28
    s_cbranch_scc1 KB_end
    s_mul_i32 s61, s20, 6144
    s_add_u32 s61, s61, 114688
    s_lshl_b32 s30, s20, 12
    s_add_u32 s30, s30, 147456
    s_add_u32 m0, s61, 0
    s_nop 0
    s_add_u32 s28, s60, 7168
    buffer_load_dwordx4 v5, s[56:59], s60 offen lds
    s_add_u32 m0, s61, 1024
    s_add_u32 s60, s60, 14336
    buffer_load_dwordx4 v5, s[56:59], s28 offen lds
    s_add_u32 m0, s61, 2048
    s_add_u32 s28, s60, 7168
    buffer_load_dwordx4 v5, s[56:59], s60 offen lds
    s_add_u32 m0, s61, 3072
    s_add_u32 s60, s60, 14336
    buffer_load_dwordx4 v5, s[56:59], s28 offen lds
    s_add_u32 m0, s61, 4096
    s_add_u32 s28, s60, 7168
    buffer_load_dwordx4 v5, s[56:59], s60 offen lds
    s_add_u32 m0, s61, 5120
    s_add_u32 s60, s60, 14336
    buffer_load_dwordx4 v5, s[56:59], s28 offen lds
    s_add_u32 m0, s30, 0
    s_add_u32 s28, s60, 7168
    buffer_load_dwordx4 v5, s[56:59], s60 offen lds
    s_add_u32 m0, s30, 1024
    s_add_u32 s60, s60, 14336
    buffer_load_dwordx4 v5, s[56:59], s28 offen lds
    s_add_u32 m0, s30, 2048
    s_add_u32 s28, s60, 7168
    buffer_load_dwordx4 v5, s[56:59], s60 offen lds
    s_add_u32 m0, s30, 3072
    s_add_u32 s60, s60, 14336
    buffer_load_dwordx4 v5, s[56:59], s28 offen lds
    v_lshrrev_b32 v132, 2, v6
    v_lshl_add_u32 v132, v7, 2, v132
    v_bfe_u32 v133, v132, 1, 2
    v_lshlrev_b32 v132, 7, v132
    v_and_b32 v134, 3, v6
    v_lshl_add_u32 v132, v134, 3, v132
    v_xor_b32_e64 v134, 0, v133
    v_lshl_add_u32 v134, v134, 5, v132
    v_add_u32 v136, s61, v134
    v_add_u32 v140, s30, v134
    v_xor_b32_e64 v134, 1, v133
    v_lshl_add_u32 v134, v134, 5, v132
    v_add_u32 v137, s61, v134
    v_add_u32 v141, s30, v134
    v_xor_b32_e64 v134, 2, v133
    v_lshl_add_u32 v134, v134, 5, v132
    v_add_u32 v138, s61, v134
    v_add_u32 v142, s30, v134
    v_xor_b32_e64 v134, 3, v133
    v_lshl_add_u32 v134, v134, 5, v132
    v_add_u32 v139, s61, v134
    v_add_u32_e64 v143, s30, v134
    s_waitcnt vmcnt(8)
    ds_read_b64_tr_b16 a[64:65], v136 offset:0
    ds_read_b64_tr_b16 a[68:69], v137 offset:0
    ds_read_b64_tr_b16 a[72:73], v138 offset:0
    ds_read_b64_tr_b16 a[76:77], v139 offset:0
    s_waitcnt lgkmcnt(0)
    s_add_u32 m0, s61, 0
    s_add_u32 s28, s60, 7168
    buffer_load_dwordx4 v5, s[56:59], s60 offen lds
    s_add_u32 m0, s61, 1024
    s_add_u32 s60, s60, 14336
    buffer_load_dwordx4 v5, s[56:59], s28 offen lds
    s_waitcnt vmcnt(8)
    ds_read_b64_tr_b16 a[66:67], v136 offset:2048
    ds_read_b64_tr_b16 a[70:71], v137 offset:2048
    ds_read_b64_tr_b16 a[74:75], v138 offset:2048
    ds_read_b64_tr_b16 a[78:79], v139 offset:2048
    s_waitcnt vmcnt(6)
    ds_read_b64_tr_b16 a[80:81], v136 offset:4096
    ds_read_b64_tr_b16 a[84:85], v137 offset:4096
    ds_read_b64_tr_b16 a[88:89], v138 offset:4096
    ds_read_b64_tr_b16 a[92:93], v139 offset:4096
    s_waitcnt vmcnt(4)
    ds_read_b64_tr_b16 a[82:83], v140 offset:0
    ds_read_b64_tr_b16 a[86:87], v141 offset:0
    ds_read_b64_tr_b16 a[90:91], v142 offset:0
    ds_read_b64_tr_b16 a[94:95], v143 offset:0
    s_waitcnt vmcnt(2)
    ds_read_b64_tr_b16 a[96:97], v140 offset:2048
    ds_read_b64_tr_b16 a[100:101], v141 offset:2048
    ds_read_b64_tr_b16 a[104:105], v142 offset:2048
    ds_read_b64_tr_b16 a[108:109], v143 offset:2048
    s_waitcnt vmcnt(0)
    ds_read_b64_tr_b16 a[98:99], v136 offset:0
    ds_read_b64_tr_b16 a[102:103], v137 offset:0
    ds_read_b64_tr_b16 a[106:107], v138 offset:0
    ds_read_b64_tr_b16 a[110:111], v139 offset:0
    s_sub_u32 s60, s60, 931840
    s_waitcnt lgkmcnt(0)
    s_add_u32 m0, s61, 0
    s_nop 0
    s_add_u32 s28, s60, 7168
    buffer_load_dwordx4 v5, s[56:59], s60 offen lds
    s_add_u32 m0, s61, 1024
    s_add_u32 s60, s60, 14336
    buffer_load_dwordx4 v5, s[56:59], s28 offen lds
    s_add_u32 m0, s61, 2048
    s_add_u32 s28, s60, 7168
    buffer_load_dwordx4 v5, s[56:59], s60 offen lds
    s_add_u32 m0, s61, 3072
    s_add_u32 s60, s60, 14336
    buffer_load_dwordx4 v5, s[56:59], s28 offen lds
    s_add_u32 m0, s61, 4096
    s_add_u32 s28, s60, 7168
    buffer_load_dwordx4 v5, s[56:59], s60 offen lds
    s_add_u32 m0, s61, 5120
    s_add_u32 s60, s60, 14336
    buffer_load_dwordx4 v5, s[56:59], s28 offen lds
    s_add_u32 m0, s30, 0
    s_add_u32 s28, s60, 7168
    buffer_load_dwordx4 v5, s[56:59], s60 offen lds
    s_add_u32 m0, s30, 1024
    s_add_u32 s60, s60, 14336
    buffer_load_dwordx4 v5, s[56:59], s28 offen lds
    s_add_u32 m0, s30, 2048
    s_add_u32 s28, s60, 7168
    buffer_load_dwordx4 v5, s[56:59], s60 offen lds
    s_add_u32 m0, s30, 3072
    s_add_u32 s60, s60, 14336
    buffer_load_dwordx4 v5, s[56:59], s28 offen lds
    s_branch KB_P3
KB_A:
    s_lshl_b32 s28, s20, 4
    v_add_u32 v9, s28, v6
    v_lshlrev_b32 v10, 2, v9
    v_lshrrev_b32 v52, 2, v6
    v_and_b32_e64 v53, 1, v6
    v_lshl_add_u32 v52, v52, 1, v53
    s_sub_u32 s40, 64, s23
    s_cmp_eq_u32 s23, 0
    s_cselect_b32 s40, 32, s40
    v_mov_b32 v53, s40
    v_mov_b32 v8, s23
    v_cmp_gt_u32 vcc, 4, v52
    s_nop 1
    v_cndmask_b32 v53, v53, v8, vcc
    v_and_b32 v8, 3, v52
    s_lshl_b32 s41, s24, 2
    v_add_u32_e64 v8, s41, v8
    v_lshl_add_u32 v53, v8, 6, v53
    v_cvt_f32_u32_e64 v53, v53
    v_mul_f32 v53, 0x3a000000, v53
    v_bfe_u32 v54, v6, 1, 1
    v_cvt_f32_u32_e64 v54, v54
    v_mul_f32 v54, 0x3e800000, v54
    v_lshlrev_b32 v55, 2, v7
    v_cvt_f32_u32 v55, v55
    v_fma_f32 v54, v55, v53, v54
    s_cmp_eq_u32 s23, 0
    s_cselect_b32 s28, 0, 0x3e800000
    s_cselect_b32 s29, 0, -1
    v_mov_b32_e64 v55, s28
    v_mov_b32 v56, 0xbe800000
    v_cndmask_b32 v55, v55, v56, vcc
    v_add_f32 v55, v55, v54
    v_mov_b32_e64 v56, s29
    v_cndmask_b32 v57, v56, -1, vcc
    v_cndmask_b32 v58, -1, v56, vcc
    v_cos_f32 v60, v54
    v_fmamk_f32 v61, v53, 0x3f800000, v54
    v_cos_f32_e64 v61, v61
    v_fmamk_f32 v62, v53, 0x40000000, v54
    v_cos_f32_e64 v62, v62
    v_fmamk_f32 v63, v53, 0x40400000, v54
    v_cos_f32_e64 v63, v63
    v_fmamk_f32 v64, v53, 0x41800000, v54
    v_cos_f32_e64 v64, v64
    v_fmamk_f32 v65, v53, 0x41880000, v54
    v_cos_f32_e64 v65, v65
    v_fmamk_f32 v66, v53, 0x41900000, v54
    v_cos_f32_e64 v66, v66
    v_fmamk_f32 v67, v53, 0x41980000, v54
    v_cos_f32_e64 v67, v67
    v_cvt_pk_bf16_f32 v16, v60, v61
    v_and_b32_e64 v16, v16, v57
    v_cvt_pk_bf16_f32 v17, v62, v63
    v_and_b32_e64 v17, v17, v57
    v_cvt_pk_bf16_f32 v18, v64, v65
    v_and_b32_e64 v18, v18, v57
    v_cvt_pk_bf16_f32 v19, v66, v67
    v_and_b32 v19, v19, v57
    v_cos_f32 v60, v55
    v_fmamk_f32 v61, v53, 0x3f800000, v55
    v_cos_f32_e64 v61, v61
    v_fmamk_f32 v62, v53, 0x40000000, v55
    v_cos_f32_e64 v62, v62
    v_fmamk_f32 v63, v53, 0x40400000, v55
    v_cos_f32_e64 v63, v63
    v_fmamk_f32 v64, v53, 0x41800000, v55
    v_cos_f32_e64 v64, v64
    v_fmamk_f32 v65, v53, 0x41880000, v55
    v_cos_f32_e64 v65, v65
    v_fmamk_f32 v66, v53, 0x41900000, v55
    v_cos_f32_e64 v66, v66
    v_fmamk_f32 v67, v53, 0x41980000, v55
    v_cos_f32_e64 v67, v67
    v_cvt_pk_bf16_f32 v20, v60, v61
    v_and_b32_e64 v20, v20, v58
    v_cvt_pk_bf16_f32 v21, v62, v63
    v_and_b32_e64 v21, v21, v58
    v_cvt_pk_bf16_f32 v22, v64, v65
    v_and_b32_e64 v22, v22, v58
    v_cvt_pk_bf16_f32 v23, v66, v67
    v_and_b32 v23, v23, v58
    s_sub_u32 s28, s2, 8
    s_cmp_ge_u32 s28, 170
    s_cbranch_scc1 KS_nopuba
    s_waitcnt vmcnt(0)
    s_barrier
    s_mov_b32 s33, 0
NL_da:
    v_readfirstlane_b32 s100, v99
    s_add_u32 s33, s33, 1
    s_cmp_lg_u32 s100, 0
    s_cbranch_scc1 ND_da
    global_load_dword v99, v98, s[50:51] sc1
    s_cmp_lt_u32 s33, 200000
    s_waitcnt vmcnt(0)
    s_cbranch_scc1 NL_da
ND_da:
    s_cmp_lg_u32 s36, 0
    s_cbranch_scc1 KS_nopuba
    v_mov_b32 v100, s100
    v_mov_b32 v101, s100
    v_mov_b32 v102, s100
    v_mov_b32 v103, s100
    s_mov_b64 exec, 0xff
    buffer_store_dwordx4 v[100:103], v15, s[16:19], s52 offen sc1
    s_mov_b64 exec, -1
KS_nopuba:
    s_cmp_ge_u32 s22, 28
    s_cbranch_scc1 KB_Aw00
KB_Aw00:
    v_mov_b32 v104, 0
    v_mov_b32 v105, 0
    v_mov_b32 v106, 0
    v_mov_b32 v107, 0
    v_mov_b32 v108, 0
    v_mov_b32 v109, 0
    v_mov_b32 v110, 0
    v_mov_b32 v111, 0
    v_mov_b32 v112, 0
    v_mov_b32 v113, 0
    v_mov_b32 v114, 0
    v_mov_b32 v115, 0
    v_mov_b32 v116, 0
    v_mov_b32 v117, 0
    v_mov_b32 v131, v10
    v_lshlrev_b32_e64 v130, 2, v2
    v_add_u32 v130, 139264, v130
    v_lshrrev_b32_e64 v8, 2, v6
    v_lshl_add_u32 v8, v7, 2, v8
    v_bfe_u32 v52, v8, 1, 2
    v_xor_b32 v52, s20, v52
    v_lshlrev_b32 v52, 5, v52
    v_lshl_add_u32 v8, v8, 7, v52
    v_and_b32_e64 v52, 3, v6
    v_lshl_add_u32 v11, v52, 3, v8
    v_add_u32 v11, 80896, v11
    v_add_u32 v12, 138240, v10
    v_cvt_f32_u32_e64 v88, v9
    v_mul_f32 v89, 0x3b124925, v88
    v_cos_f32 v118, v89
    v_sin_f32 v119, v89
    v_mul_f32 v89, 0x3b924925, v88
    v_cos_f32 v120, v89
    v_sin_f32 v121, v89
    v_mul_f32 v89, 0x3bdb6db7, v88
    v_cos_f32 v122, v89
    v_sin_f32 v123, v89
    v_mul_f32 v89, 0x3c124925, v88
    v_cos_f32 v124, v89
    v_sin_f32 v125, v89
    v_mul_f32 v89, 0x3c36db6e, v88
    v_cos_f32 v126, v89
    v_sin_f32 v127, v89
    v_mul_f32 v89, 0x3c5b6db7, v88
    v_cos_f32 v128, v89
    v_sin_f32 v129, v89
    v_bfe_u32 v88, v6, 1, 1
    v_xor_b32 v88, s20, v88
    v_and_b32 v89, 3, v6
    v_lshl_add_u32 v88, v89, 2, v88
    v_lshrrev_b32_e64 v89, 2, v6
    v_lshl_add_u32 v88, v88, 2, v89
    v_mul_u32_u24 v89, 4352, v7
    v_lshl_add_u32 v10, v88, 2, v89
    v_add_u32 v10, 146432, v10
    v_add_u32 v94, 1088, v10
    v_add_u32 v103, 2176, v10
    v_add_u32 v13, 3264, v10
    s_cmp_ge_u32 s22, 28
    s_cbranch_scc1 KB_Aw0
    v_lshrrev_b32_e64 v132, 2, v6
    v_lshl_add_u32 v132, v7, 2, v132
    v_bfe_u32 v133, v132, 1, 2
    v_lshlrev_b32 v132, 7, v132
    v_and_b32 v134, 3, v6
    v_lshl_add_u32 v132, v134, 3, v132
    v_xor_b32_e64 v134, 0, v133
    v_lshl_add_u32 v134, v134, 5, v132
    v_add_u32 v136, s61, v134
    v_xor_b32 v134, 1, v133
    v_lshl_add_u32 v134, v134, 5, v132
    v_add_u32 v137, s61, v134
    v_xor_b32 v134, 2, v133
    v_lshl_add_u32 v134, v134, 5, v132
    v_add_u32 v138, s61, v134
    v_xor_b32 v134, 3, v133
    v_lshl_add_u32 v134, v134, 5, v132
    v_add_u32 v139, s61, v134
KB_Aw0:
    s_sub_u32 s28, s2, 8
    s_cmp_lt_u32 s28, 170
    s_cbranch_scc1 KS_hna
    s_waitcnt vmcnt(0)
    s_mov_b32 s33, 0
NL_la:
    v_readfirstlane_b32 s100, v99
    s_add_u32 s33, s33, 1
    s_cmp_lg_u32 s100, 0
    s_cbranch_scc1 ND_la
    global_load_dword v99, v98, s[50:51] sc1
    s_cmp_lt_u32 s33, 200000
    s_waitcnt vmcnt(0)
    s_cbranch_scc1 NL_la
ND_la:
KS_hna:
    s_waitcnt lgkmcnt(0)
    v_bfe_u32 v14, v3, 1, 1
    v_xor_b32_e64 v14, v14, v4
    v_mul_u32_u24 v8, 3584, v3
    v_lshl_add_u32 v14, v14, 4, v8
    v_xor_b32_e64 v1, 64, v14
    s_mov_b32 s44, s8
    s_mov_b32 s45, s9
    s_mov_b32 s46, 1605632
    s_mov_b32 s47, 0x00020000
    s_mov_b32 s48, s10
    s_mov_b32 s49, s11
    s_mov_b32 s50, 1605632
    s_mov_b32 s51, 0x00020000
    s_add_u32 s28, s20, 12
    s_mul_i32 s26, s28, 28672
    s_lshl_b32 s32, s38, 7
    s_add_u32 s26, s26, s32
    s_lshl_b32 s27, s28, 11
    s_mul_i32 s61, s20, 6144
    s_add_u32 s61, s61, 114688
    v_lshrrev_b32_e64 v132, 2, v6
    v_lshl_add_u32 v132, v7, 2, v132
    v_bfe_u32 v133, v132, 1, 2
    v_lshlrev_b32 v132, 7, v132
    v_and_b32 v134, 3, v6
    v_lshl_add_u32 v132, v134, 3, v132
    v_xor_b32_e64 v134, 0, v133
    v_lshl_add_u32 v134, v134, 5, v132
    v_add_u32 v136, s61, v134
    v_add_u32 v140, s27, v134
    v_xor_b32_e64 v134, 1, v133
    v_lshl_add_u32 v134, v134, 5, v132
    v_add_u32 v137, s61, v134
    v_add_u32 v141, s27, v134
    v_xor_b32_e64 v134, 2, v133
    v_lshl_add_u32 v134, v134, 5, v132
    v_add_u32 v138, s61, v134
    v_add_u32 v142, s27, v134
    v_xor_b32_e64 v134, 3, v133
    v_lshl_add_u32 v134, v134, 5, v132
    v_add_u32 v139, s61, v134
    v_add_u32 v143, s27, v134
    s_mov_b32 s16, s34
    s_mov_b32 s17, s35
    s_mov_b32 s18, 1605632
    s_mov_b32 s19, 0x00020000
    s_mov_b32 s54, 0x3f1f9d07
    s_mov_b32 s55, 0x3f48261c
    s_mov_b32 s56, 0xbe63dc87
    s_mov_b32 s57, 0x3f7994e0
    s_mov_b32 s58, 0xbf66a5e5
    s_mov_b32 s59, 0x3ede2602
    s_waitcnt lgkmcnt(0)
    s_setprio 3
    s_barrier
    s_lshl_b32 s29, s20, 9
    s_add_u32 m0, s29, 138240
    s_add_u32 s29, s29, 1835008
    s_cmp_eq_u32 s20, 3
    s_cselect_b32 exec_lo, 0xffff, -1
    s_mov_b32 exec_hi, 0
    buffer_load_dwordx4 v15, s[12:15], s29 offen sc1 lds
    s_mov_b64 exec, -1
    s_add_u32 m0, s3, 0
    s_add_u32 s28, s101, 0
    s_nop 0
    buffer_load_dwordx4 v5, s[12:15], s28 offen sc1 lds
    s_add_u32 m0, s3, 1024
    s_add_u32 s28, s101, 7168
    buffer_load_dwordx4 v5, s[12:15], s28 offen sc1 lds
    s_add_u32 m0, s3, 8192
    s_add_u32 s28, s101, 128
    buffer_load_dwordx4 v5, s[12:15], s28 offen sc1 lds
    s_add_u32 m0, s3, 9216
    s_add_u32 s28, s101, 7296
    buffer_load_dwordx4 v5, s[12:15], s28 offen sc1 lds
    s_add_u32 m0, s3, 49152
    s_add_u32 s28, s101, 768
    buffer_load_dwordx4 v5, s[12:15], s28 offen sc1 lds
    s_add_u32 m0, s3, 50176
    s_add_u32 s28, s101, 7936
    buffer_load_dwordx4 v5, s[12:15], s28 offen sc1 lds
    s_setprio 0
    s_cmp_lg_u32 s25, 0
    s_cbranch_scc1 KB_nosa
    s_mov_b32 s29, 1843200
    s_mov_b64 exec, 0xffff
    buffer_load_dword v104, v131, s[12:15], s29 offen offset:0 sc1
    buffer_load_dword v106, v131, s[12:15], s29 offen offset:256 sc1
    buffer_load_dword v108, v131, s[12:15], s29 offen offset:512 sc1
    buffer_load_dword v110, v131, s[12:15], s29 offen offset:768 sc1
    buffer_load_dword v112, v131, s[12:15], s29 offen offset:1024 sc1
    buffer_load_dword v114, v131, s[12:15], s29 offen offset:1280 sc1
    buffer_load_dword v116, v131, s[12:15], s29 offen offset:1536 sc1
    s_mov_b64 exec, -1
KB_nosa:
    s_waitcnt vmcnt(0)
    s_setprio 2
    s_setprio 2
    s_barrier
    ds_read_b64_tr_b16 v[64:65], v11 offset:0
    ds_read_b64_tr_b16 v[66:67], v11 offset:2048
    ds_read_b64_tr_b16 v[68:69], v11 offset:4096
    ds_read_b64_tr_b16 v[70:71], v11 offset:6144
    ds_read_b64_tr_b16 v[72:73], v11 offset:8192
    ds_read_b64_tr_b16 v[74:75], v11 offset:10240
    ds_read_b64_tr_b16 v[76:77], v11 offset:12288
    ds_read_b64_tr_b16 v[78:79], v11 offset:14336
    ds_read_b64_tr_b16 v[80:81], v11 offset:49152
    ds_read_b64_tr_b16 v[82:83], v11 offset:51200
    ds_read_b64_tr_b16 v[84:85], v11 offset:53248
    ds_read_b64_tr_b16 v[86:87], v11 offset:55296
    s_waitcnt lgkmcnt(10)
    ds_read2st64_b32 v[96:97], v12 offset0:0 offset1:1
    ds_read2st64_b32 v[98:99], v12 offset0:2 offset1:3
    ds_read2st64_b32 v[100:101], v12 offset0:4 offset1:5
    ds_read_b32 v102, v12 offset:1536
    s_waitcnt lgkmcnt(14)
    v_mfma_f32_16x16x32_bf16 v[24:27], v[16:19], v[64:67], 0
    s_waitcnt lgkmcnt(12)
    v_mfma_f32_16x16x32_bf16 v[24:27], v[20:23], v[68:71], v[24:27]
    s_waitcnt lgkmcnt(10)
    v_mfma_f32_16x16x32_bf16 v[28:31], v[16:19], v[72:75], 0
    s_waitcnt lgkmcnt(8)
    v_mfma_f32_16x16x32_bf16 v[28:31], v[20:23], v[76:79], v[28:31]
    s_waitcnt lgkmcnt(6)
    v_mfma_f32_16x16x32_bf16 v[48:51], v[16:19], v[80:83], 0
    s_waitcnt lgkmcnt(4)
    v_mfma_f32_16x16x32_bf16 v[48:51], v[20:23], v[84:87], v[48:51]
    s_barrier
    ds_read_b64_tr_b16 v[36:37], v11 offset:16384
    ds_read_b64_tr_b16 v[38:39], v11 offset:18432
    ds_read_b64_tr_b16 v[40:41], v11 offset:20480
    ds_read_b64_tr_b16 v[42:43], v11 offset:22528
    ds_read_b64_tr_b16 v[56:57], v11 offset:40960
    ds_read_b64_tr_b16 v[58:59], v11 offset:43008
    ds_read_b64_tr_b16 v[60:61], v11 offset:45056
    ds_read_b64_tr_b16 v[62:63], v11 offset:47104
    s_waitcnt lgkmcnt(8)
    s_nop 0
    v_pk_fma_f32 v[24:25], v[24:25], v[96:97], v[104:105] op_sel:[0,0,0] op_sel_hi:[1,0,1]
    v_pk_mul_f32 v[26:27], v[26:27], v[96:97] op_sel:[0,0] op_sel_hi:[1,0]
    v_pk_fma_f32 v[28:29], v[28:29], v[96:97], v[106:107] op_sel:[0,1,0] op_sel_hi:[1,1,1]
    v_pk_mul_f32 v[30:31], v[30:31], v[96:97] op_sel:[0,1] op_sel_hi:[1,1]
    v_pk_fma_f32 v[48:49], v[48:49], v[102:103], v[116:117] op_sel:[0,0,0] op_sel_hi:[1,0,1]
    v_pk_mul_f32 v[50:51], v[50:51], v[102:103] op_sel:[0,0] op_sel_hi:[1,0]
    v_pk_add_f32 v[52:53], v[28:29], v[48:49]
    v_pk_add_f32 v[28:29], v[28:29], v[48:49] neg_lo:[0,1] neg_hi:[0,1]
    v_pk_add_f32 v[54:55], v[30:31], v[50:51]
    v_pk_add_f32 v[30:31], v[30:31], v[50:51] neg_lo:[0,1] neg_hi:[0,1]
    v_pk_fma_f32 v[64:65], v[52:53], s[54:55], v[24:25] op_sel:[0,0,0] op_sel_hi:[1,0,1]
    v_pk_mul_f32 v[76:77], v[28:29], s[54:55] op_sel:[0,1] op_sel_hi:[1,1] neg_lo:[0,0] neg_hi:[0,0]
    v_pk_fma_f32 v[66:67], v[54:55], s[54:55], v[26:27] op_sel:[0,0,0] op_sel_hi:[1,0,1]
    v_pk_mul_f32 v[78:79], v[30:31], s[54:55] op_sel:[0,1] op_sel_hi:[1,1] neg_lo:[0,0] neg_hi:[0,0]
    v_pk_fma_f32 v[68:69], v[52:53], s[56:57], v[24:25] op_sel:[0,0,0] op_sel_hi:[1,0,1]
    v_pk_mul_f32 v[80:81], v[28:29], s[56:57] op_sel:[0,1] op_sel_hi:[1,1] neg_lo:[0,0] neg_hi:[0,0]
    v_pk_fma_f32 v[70:71], v[54:55], s[56:57], v[26:27] op_sel:[0,0,0] op_sel_hi:[1,0,1]
    v_pk_mul_f32 v[82:83], v[30:31], s[56:57] op_sel:[0,1] op_sel_hi:[1,1] neg_lo:[0,0] neg_hi:[0,0]
    v_pk_fma_f32 v[72:73], v[52:53], s[58:59], v[24:25] op_sel:[0,0,0] op_sel_hi:[1,0,1]
    v_pk_mul_f32 v[84:85], v[28:29], s[58:59] op_sel:[0,1] op_sel_hi:[1,1] neg_lo:[0,0] neg_hi:[0,0]
    v_pk_fma_f32 v[74:75], v[54:55], s[58:59], v[26:27] op_sel:[0,0,0] op_sel_hi:[1,0,1]
    v_pk_mul_f32 v[86:87], v[30:31], s[58:59] op_sel:[0,1] op_sel_hi:[1,1] neg_lo:[0,0] neg_hi:[0,0]
    v_pk_add_f32 v[24:25], v[24:25], v[52:53]
    v_pk_add_f32 v[26:27], v[26:27], v[54:55]
    s_waitcnt lgkmcnt(0)
    v_mfma_f32_16x16x32_bf16 v[32:35], v[16:19], v[36:39], 0
    v_mfma_f32_16x16x32_bf16 v[32:35], v[20:23], v[40:43], v[32:35]
    v_mfma_f32_16x16x32_bf16 v[44:47], v[16:19], v[56:59], 0
    v_mfma_f32_16x16x32_bf16 v[44:47], v[20:23], v[60:63], v[44:47]
    s_barrier
    ds_read_b64_tr_b16 v[48:49], v11 offset:24576
    ds_read_b64_tr_b16 v[50:51], v11 offset:26624
    ds_read_b64_tr_b16 v[52:53], v11 offset:28672
    ds_read_b64_tr_b16 v[54:55], v11 offset:30720
    ds_read_b64_tr_b16 v[60:61], v11 offset:32768
    ds_read_b64_tr_b16 v[62:63], v11 offset:34816
    ds_read_b64_tr_b16 v[88:89], v11 offset:36864
    ds_read_b64_tr_b16 v[90:91], v11 offset:38912
    v_pk_fma_f32 v[32:33], v[32:33], v[98:99], v[108:109] op_sel:[0,0,0] op_sel_hi:[1,0,1]
    v_pk_mul_f32 v[34:35], v[34:35], v[98:99] op_sel:[0,0] op_sel_hi:[1,0]
    v_pk_fma_f32 v[44:45], v[44:45], v[100:101], v[114:115] op_sel:[0,1,0] op_sel_hi:[1,1,1]
    v_pk_mul_f32 v[46:47], v[46:47], v[100:101] op_sel:[0,1] op_sel_hi:[1,1]
    v_pk_add_f32 v[56:57], v[32:33], v[44:45]
    v_pk_add_f32 v[32:33], v[32:33], v[44:45] neg_lo:[0,1] neg_hi:[0,1]
    v_pk_add_f32 v[58:59], v[34:35], v[46:47]
    v_pk_add_f32 v[34:35], v[34:35], v[46:47] neg_lo:[0,1] neg_hi:[0,1]
    v_pk_fma_f32 v[64:65], v[56:57], s[56:57], v[64:65] op_sel:[0,0,0] op_sel_hi:[1,0,1]
    v_pk_fma_f32 v[76:77], v[32:33], s[56:57], v[76:77] op_sel:[0,1,0] op_sel_hi:[1,1,1] neg_lo:[0,0,0] neg_hi:[0,0,0]
    v_pk_fma_f32 v[66:67], v[58:59], s[56:57], v[66:67] op_sel:[0,0,0] op_sel_hi:[1,0,1]
    v_pk_fma_f32 v[78:79], v[34:35], s[56:57], v[78:79] op_sel:[0,1,0] op_sel_hi:[1,1,1] neg_lo:[0,0,0] neg_hi:[0,0,0]
    v_pk_fma_f32 v[68:69], v[56:57], s[58:59], v[68:69] op_sel:[0,0,0] op_sel_hi:[1,0,1]
    v_pk_fma_f32 v[80:81], v[32:33], s[58:59], v[80:81] op_sel:[0,1,0] op_sel_hi:[1,1,1] neg_lo:[1,0,0] neg_hi:[1,0,0]
    v_pk_fma_f32 v[70:71], v[58:59], s[58:59], v[70:71] op_sel:[0,0,0] op_sel_hi:[1,0,1]
    v_pk_fma_f32 v[82:83], v[34:35], s[58:59], v[82:83] op_sel:[0,1,0] op_sel_hi:[1,1,1] neg_lo:[1,0,0] neg_hi:[1,0,0]
    v_pk_fma_f32 v[72:73], v[56:57], s[54:55], v[72:73] op_sel:[0,0,0] op_sel_hi:[1,0,1]
    v_pk_fma_f32 v[84:85], v[32:33], s[54:55], v[84:85] op_sel:[0,1,0] op_sel_hi:[1,1,1] neg_lo:[1,0,0] neg_hi:[1,0,0]
    v_pk_fma_f32 v[74:75], v[58:59], s[54:55], v[74:75] op_sel:[0,0,0] op_sel_hi:[1,0,1]
    v_pk_fma_f32 v[86:87], v[34:35], s[54:55], v[86:87] op_sel:[0,1,0] op_sel_hi:[1,1,1] neg_lo:[1,0,0] neg_hi:[1,0,0]
    v_pk_add_f32 v[24:25], v[24:25], v[56:57]
    v_pk_add_f32 v[26:27], v[26:27], v[58:59]
    s_waitcnt lgkmcnt(0)
    v_mfma_f32_16x16x32_bf16 v[36:39], v[16:19], v[48:51], 0
    v_mfma_f32_16x16x32_bf16 v[36:39], v[20:23], v[52:55], v[36:39]
    v_mfma_f32_16x16x32_bf16 v[40:43], v[16:19], v[60:63], 0
    v_mfma_f32_16x16x32_bf16 v[40:43], v[20:23], v[88:91], v[40:43]
    ds_write_b32 v130, v105
    s_nop 4
    v_pk_fma_f32 v[36:37], v[36:37], v[98:99], v[110:111] op_sel:[0,1,0] op_sel_hi:[1,1,1]
    v_pk_mul_f32 v[38:39], v[38:39], v[98:99] op_sel:[0,1] op_sel_hi:[1,1]
    v_pk_fma_f32 v[40:41], v[40:41], v[100:101], v[112:113] op_sel:[0,0,0] op_sel_hi:[1,0,1]
    v_pk_mul_f32 v[42:43], v[42:43], v[100:101] op_sel:[0,0] op_sel_hi:[1,0]
    v_pk_add_f32 v[60:61], v[36:37], v[40:41]
    v_pk_add_f32 v[36:37], v[36:37], v[40:41] neg_lo:[0,1] neg_hi:[0,1]
    v_pk_add_f32 v[62:63], v[38:39], v[42:43]
    v_pk_add_f32 v[38:39], v[38:39], v[42:43] neg_lo:[0,1] neg_hi:[0,1]
    v_pk_fma_f32 v[64:65], v[60:61], s[58:59], v[64:65] op_sel:[0,0,0] op_sel_hi:[1,0,1]
    v_pk_fma_f32 v[76:77], v[36:37], s[58:59], v[76:77] op_sel:[0,1,0] op_sel_hi:[1,1,1] neg_lo:[0,0,0] neg_hi:[0,0,0]
    v_pk_fma_f32 v[66:67], v[62:63], s[58:59], v[66:67] op_sel:[0,0,0] op_sel_hi:[1,0,1]
    v_pk_fma_f32 v[78:79], v[38:39], s[58:59], v[78:79] op_sel:[0,1,0] op_sel_hi:[1,1,1] neg_lo:[0,0,0] neg_hi:[0,0,0]
    v_pk_add_f32 v[44:45], v[64:65], v[78:79]
    v_pk_add_f32 v[46:47], v[66:67], v[76:77] neg_lo:[0,1] neg_hi:[0,1]
    v_pk_add_f32 v[48:49], v[64:65], v[78:79] neg_lo:[0,1] neg_hi:[0,1]
    v_pk_add_f32 v[50:51], v[66:67], v[76:77]
    v_pk_mul_f32 v[52:53], v[44:45], v[118:119] op_sel:[0,0] op_sel_hi:[1,0]
    v_pk_mul_f32 v[54:55], v[46:47], v[118:119] op_sel:[0,0] op_sel_hi:[1,0]
    v_pk_fma_f32 v[52:53], v[46:47], v[118:119], v[52:53] op_sel:[0,1,0] op_sel_hi:[1,1,1]
    v_pk_fma_f32 v[54:55], v[44:45], v[118:119], v[54:55] op_sel:[0,1,0] op_sel_hi:[1,1,1] neg_lo:[1,0,0] neg_hi:[1,0,0]
    v_cvt_pk_bf16_f32 v88, v52, v54
    v_cvt_pk_bf16_f32 v89, v53, v55
    ds_write2_b32 v10, v88, v89 offset0:136 offset1:204
    v_pk_mul_f32 v[56:57], v[48:49], v[128:129] op_sel:[0,0] op_sel_hi:[1,0]
    v_pk_mul_f32 v[58:59], v[50:51], v[128:129] op_sel:[0,0] op_sel_hi:[1,0]
    v_pk_fma_f32 v[56:57], v[50:51], v[128:129], v[56:57] op_sel:[0,1,0] op_sel_hi:[1,1,1]
    v_pk_fma_f32 v[58:59], v[48:49], v[128:129], v[58:59] op_sel:[0,1,0] op_sel_hi:[1,1,1] neg_lo:[1,0,0] neg_hi:[1,0,0]
    v_cvt_pk_bf16_f32 v90, v56, v58
    v_cvt_pk_bf16_f32 v91, v57, v59
    ds_write2_b32 v13, v90, v91 offset0:0 offset1:68
    v_pk_fma_f32 v[68:69], v[60:61], s[54:55], v[68:69] op_sel:[0,0,0] op_sel_hi:[1,0,1]
    v_pk_fma_f32 v[80:81], v[36:37], s[54:55], v[80:81] op_sel:[0,1,0] op_sel_hi:[1,1,1] neg_lo:[1,0,0] neg_hi:[1,0,0]
    v_pk_fma_f32 v[70:71], v[62:63], s[54:55], v[70:71] op_sel:[0,0,0] op_sel_hi:[1,0,1]
    v_pk_fma_f32 v[82:83], v[38:39], s[54:55], v[82:83] op_sel:[0,1,0] op_sel_hi:[1,1,1] neg_lo:[1,0,0] neg_hi:[1,0,0]
    v_pk_add_f32 v[44:45], v[68:69], v[82:83]
    v_pk_add_f32 v[46:47], v[70:71], v[80:81] neg_lo:[0,1] neg_hi:[0,1]
    v_pk_add_f32 v[48:49], v[68:69], v[82:83] neg_lo:[0,1] neg_hi:[0,1]
    v_pk_add_f32 v[50:51], v[70:71], v[80:81]
    v_pk_mul_f32 v[52:53], v[44:45], v[120:121] op_sel:[0,0] op_sel_hi:[1,0]
    v_pk_mul_f32 v[54:55], v[46:47], v[120:121] op_sel:[0,0] op_sel_hi:[1,0]
    v_pk_fma_f32 v[52:53], v[46:47], v[120:121], v[52:53] op_sel:[0,1,0] op_sel_hi:[1,1,1]
    v_pk_fma_f32 v[54:55], v[44:45], v[120:121], v[54:55] op_sel:[0,1,0] op_sel_hi:[1,1,1] neg_lo:[1,0,0] neg_hi:[1,0,0]
    v_cvt_pk_bf16_f32 v88, v52, v54
    v_cvt_pk_bf16_f32 v89, v53, v55
    ds_write2_b32 v94, v88, v89 offset0:0 offset1:68
    v_pk_mul_f32 v[56:57], v[48:49], v[126:127] op_sel:[0,0] op_sel_hi:[1,0]
    v_pk_mul_f32 v[58:59], v[50:51], v[126:127] op_sel:[0,0] op_sel_hi:[1,0]
    v_pk_fma_f32 v[56:57], v[50:51], v[126:127], v[56:57] op_sel:[0,1,0] op_sel_hi:[1,1,1]
    v_pk_fma_f32 v[58:59], v[48:49], v[126:127], v[58:59] op_sel:[0,1,0] op_sel_hi:[1,1,1] neg_lo:[1,0,0] neg_hi:[1,0,0]
    v_cvt_pk_bf16_f32 v90, v56, v58
    v_cvt_pk_bf16_f32 v91, v57, v59
    ds_write2_b32 v103, v90, v91 offset0:136 offset1:204
    v_pk_fma_f32 v[72:73], v[60:61], s[56:57], v[72:73] op_sel:[0,0,0] op_sel_hi:[1,0,1]
    v_pk_fma_f32 v[84:85], v[36:37], s[56:57], v[84:85] op_sel:[0,1,0] op_sel_hi:[1,1,1] neg_lo:[0,0,0] neg_hi:[0,0,0]
    v_pk_fma_f32 v[74:75], v[62:63], s[56:57], v[74:75] op_sel:[0,0,0] op_sel_hi:[1,0,1]
    v_pk_fma_f32 v[86:87], v[38:39], s[56:57], v[86:87] op_sel:[0,1,0] op_sel_hi:[1,1,1] neg_lo:[0,0,0] neg_hi:[0,0,0]
    v_pk_add_f32 v[44:45], v[72:73], v[86:87]
    v_pk_add_f32 v[46:47], v[74:75], v[84:85] neg_lo:[0,1] neg_hi:[0,1]
    v_pk_add_f32 v[48:49], v[72:73], v[86:87] neg_lo:[0,1] neg_hi:[0,1]
    v_pk_add_f32 v[50:51], v[74:75], v[84:85]
    v_pk_mul_f32 v[52:53], v[44:45], v[122:123] op_sel:[0,0] op_sel_hi:[1,0]
    v_pk_mul_f32 v[54:55], v[46:47], v[122:123] op_sel:[0,0] op_sel_hi:[1,0]
    v_pk_fma_f32 v[52:53], v[46:47], v[122:123], v[52:53] op_sel:[0,1,0] op_sel_hi:[1,1,1]
    v_pk_fma_f32 v[54:55], v[44:45], v[122:123], v[54:55] op_sel:[0,1,0] op_sel_hi:[1,1,1] neg_lo:[1,0,0] neg_hi:[1,0,0]
    v_cvt_pk_bf16_f32 v88, v52, v54
    v_cvt_pk_bf16_f32 v89, v53, v55
    ds_write2_b32 v94, v88, v89 offset0:136 offset1:204
    v_pk_mul_f32 v[56:57], v[48:49], v[124:125] op_sel:[0,0] op_sel_hi:[1,0]
    v_pk_mul_f32 v[58:59], v[50:51], v[124:125] op_sel:[0,0] op_sel_hi:[1,0]
    v_pk_fma_f32 v[56:57], v[50:51], v[124:125], v[56:57] op_sel:[0,1,0] op_sel_hi:[1,1,1]
    v_pk_fma_f32 v[58:59], v[48:49], v[124:125], v[58:59] op_sel:[0,1,0] op_sel_hi:[1,1,1] neg_lo:[1,0,0] neg_hi:[1,0,0]
    v_cvt_pk_bf16_f32 v90, v56, v58
    v_cvt_pk_bf16_f32 v91, v57, v59
    ds_write2_b32 v103, v90, v91 offset0:0 offset1:68
    v_pk_add_f32 v[24:25], v[24:25], v[60:61]
    v_pk_add_f32 v[26:27], v[26:27], v[62:63]
    v_cvt_pk_bf16_f32 v92, v24, v26
    v_cvt_pk_bf16_f32 v93, v25, v27
    ds_write2_b32 v10, v92, v93 offset0:0 offset1:68
    s_waitcnt lgkmcnt(0)
    s_setprio 0
    s_barrier
    s_cmp_ge_u32 s22, 28
    s_cbranch_scc1 KB_Aspare
    s_add_u32 m0, s61, 0
    s_add_u32 s28, s60, 7168
    buffer_load_dwordx4 v5, s[16:19], s60 offen lds
    s_add_u32 m0, s61, 1024
    s_add_u32 s60, s60, 14336
    buffer_load_dwordx4 v5, s[16:19], s28 offen lds
    s_add_u32 m0, s61, 2048
    s_add_u32 s28, s60, 7168
    buffer_load_dwordx4 v5, s[16:19], s60 offen lds
    s_add_u32 m0, s61, 3072
    s_add_u32 s60, s60, 14336
    buffer_load_dwordx4 v5, s[16:19], s28 offen lds
    s_add_u32 m0, s61, 4096
    s_add_u32 s28, s60, 7168
    buffer_load_dwordx4 v5, s[16:19], s60 offen lds
    s_add_u32 m0, s61, 5120
    s_add_u32 s60, s60, 14336
    buffer_load_dwordx4 v5, s[16:19], s28 offen lds
    s_waitcnt vmcnt(4)
    s_add_u32 m0, s27, 0
    s_add_u32 s28, s60, 7168
    buffer_load_dwordx4 v5, s[16:19], s60 offen lds
    s_add_u32 m0, s27, 1024
    s_add_u32 s60, s60, 14336
    buffer_load_dwordx4 v5, s[16:19], s28 offen lds
    ds_read_b64_tr_b16 a[0:1], v136 offset:0
    ds_read_b64_tr_b16 a[4:5], v137 offset:0
    ds_read_b64_tr_b16 a[8:9], v138 offset:0
    ds_read_b64_tr_b16 a[12:13], v139 offset:0
    s_waitcnt lgkmcnt(0)
    s_waitcnt vmcnt(4)
    s_add_u32 m0, s27, 8192
    s_add_u32 s28, s60, 7168
    buffer_load_dwordx4 v5, s[16:19], s60 offen lds
    s_add_u32 m0, s27, 9216
    s_add_u32 s60, s60, 14336
    buffer_load_dwordx4 v5, s[16:19], s28 offen lds
    ds_read_b64_tr_b16 a[2:3], v136 offset:2048
    ds_read_b64_tr_b16 a[6:7], v137 offset:2048
    ds_read_b64_tr_b16 a[10:11], v138 offset:2048
    ds_read_b64_tr_b16 a[14:15], v139 offset:2048
    s_waitcnt lgkmcnt(0)
    s_waitcnt vmcnt(4)
    s_add_u32 m0, s27, 16384
    s_add_u32 s28, s26, 229376
    buffer_load_dwordx4 v14, s[44:47], s28 offen lds
    s_add_u32 m0, s27, 17408
    s_add_u32 s28, s26, 229376
    buffer_load_dwordx4 v1, s[48:51], s28 offen lds
    ds_read_b64_tr_b16 a[16:17], v136 offset:4096
    ds_read_b64_tr_b16 a[20:21], v137 offset:4096
    ds_read_b64_tr_b16 a[24:25], v138 offset:4096
    ds_read_b64_tr_b16 a[28:29], v139 offset:4096
    s_waitcnt lgkmcnt(0)
    s_waitcnt vmcnt(4)
    s_add_u32 m0, s27, 24576
    s_add_u32 s28, s26, 344064
    buffer_load_dwordx4 v14, s[44:47], s28 offen lds
    s_add_u32 m0, s27, 25600
    s_add_u32 s28, s26, 344064
    buffer_load_dwordx4 v1, s[48:51], s28 offen lds
    ds_read_b64_tr_b16 a[18:19], v140 offset:0
    ds_read_b64_tr_b16 a[22:23], v141 offset:0
    ds_read_b64_tr_b16 a[26:27], v142 offset:0
    ds_read_b64_tr_b16 a[30:31], v143 offset:0
    s_waitcnt lgkmcnt(0)
    s_waitcnt vmcnt(4)
    s_add_u32 m0, s27, 32768
    s_add_u32 s28, s26, 458752
    buffer_load_dwordx4 v14, s[44:47], s28 offen lds
    s_add_u32 m0, s27, 33792
    s_add_u32 s28, s26, 458752
    buffer_load_dwordx4 v1, s[48:51], s28 offen lds
    ds_read_b64_tr_b16 a[32:33], v140 offset:8192
    ds_read_b64_tr_b16 a[36:37], v141 offset:8192
    ds_read_b64_tr_b16 a[40:41], v142 offset:8192
    ds_read_b64_tr_b16 a[44:45], v143 offset:8192
    s_waitcnt lgkmcnt(0)
    s_waitcnt vmcnt(4)
    s_add_u32 m0, s27, 40960
    s_add_u32 s28, s26, 573440
    buffer_load_dwordx4 v14, s[44:47], s28 offen lds
    s_add_u32 m0, s27, 41984
    s_add_u32 s28, s26, 573440
    buffer_load_dwordx4 v1, s[48:51], s28 offen lds
    s_waitcnt vmcnt(4)
    s_add_u32 m0, s27, 49152
    s_add_u32 s28, s26, 688128
    buffer_load_dwordx4 v14, s[44:47], s28 offen lds
    s_add_u32 m0, s27, 50176
    s_add_u32 s28, s26, 688128
    buffer_load_dwordx4 v1, s[48:51], s28 offen lds
    s_waitcnt vmcnt(4)
    s_add_u32 m0, s27, 57344
    s_add_u32 s28, s26, 802816
    buffer_load_dwordx4 v14, s[44:47], s28 offen lds
    s_add_u32 m0, s27, 58368
    s_add_u32 s28, s26, 802816
    buffer_load_dwordx4 v1, s[48:51], s28 offen lds
    s_waitcnt vmcnt(4)
    s_add_u32 m0, s27, 65536
    s_add_u32 s28, s26, 917504
    buffer_load_dwordx4 v14, s[44:47], s28 offen lds
    s_add_u32 m0, s27, 66560
    s_add_u32 s28, s26, 917504
    buffer_load_dwordx4 v1, s[48:51], s28 offen lds
    v_and_b32 v8, 3, v2
    v_lshlrev_b32_e64 v8, 2, v8
    v_add_u32 v8, 139440, v8
    s_mov_b32 s33, 0
KW_fw:
    ds_read_b32 v9, v8 offset:1
    s_add_u32 s33, s33, 1
    s_waitcnt lgkmcnt(0)
    v_cmp_eq_u32 vcc, 0, v9
    s_nop 0
    s_cbranch_vccz KWD_fw
    s_cmp_lt_u32 s33, 800000
    s_cbranch_scc1 KW_fw
KWD_fw:
    s_nop 0
    s_add_u32 m0, s27, 73728
    s_add_u32 s28, s26, 1032192
    buffer_load_dwordx4 v14, s[44:47], s28 offen lds
    s_add_u32 m0, s27, 74752
    s_add_u32 s28, s26, 1032192
    buffer_load_dwordx4 v1, s[48:51], s28 offen lds
    s_add_u32 m0, s27, 81920
    s_add_u32 s28, s26, 1146880
    buffer_load_dwordx4 v14, s[44:47], s28 offen lds
    s_add_u32 m0, s27, 82944
    s_add_u32 s28, s26, 1146880
    buffer_load_dwordx4 v1, s[48:51], s28 offen lds
    s_add_u32 m0, s27, 0
    s_add_u32 s28, s26, 0
    buffer_load_dwordx4 v14, s[44:47], s28 offen lds
    s_add_u32 m0, s27, 1024
    s_add_u32 s28, s26, 0
    buffer_load_dwordx4 v1, s[48:51], s28 offen lds
    s_waitcnt vmcnt(10)
    s_add_u32 m0, s27, 8192
    s_add_u32 s28, s26, 114688
    buffer_load_dwordx4 v14, s[44:47], s28 offen lds
    s_add_u32 m0, s27, 9216
    s_add_u32 s28, s26, 114688
    buffer_load_dwordx4 v1, s[48:51], s28 offen lds
    s_waitcnt lgkmcnt(0)
    s_branch KB_P3
KB_Aspare:
    s_barrier
    s_branch KB_end
KB_P3:
    s_lshl_b32 s43, s37, 3
    s_add_u32 s43, s43, s36
    s_lshl_b32 s29, s43, 11
    v_lshlrev_b32 v13, 7, v6
    s_add_u32 s12, s6, 14680064
    s_addc_u32 s13, s7, 0
    s_mov_b32 s14, 557056
    s_mov_b32 s15, 0x00020000
    buffer_load_dword v15, v13, s[12:15], s29 offen sc1
    s_mov_b32 s52, 0
    v_bfe_u32 v16, v2, 2, 2
    v_lshlrev_b32_e64 v17, 7, v16
    v_lshl_add_u32 v17, v7, 10, v17
    v_and_b32_e64 v18, 1, v2
    v_lshl_add_u32 v17, v18, 3, v17
    v_lshrrev_b32 v16, 1, v16
    v_and_b32 v18, 1, v7
    v_lshl_add_u32 v16, v18, 2, v16
    v_and_b32 v18, 2, v2
    v_xor_b32 v16, v16, v18
    s_mov_b32 s53, s52
    s_lshl_b32 s28, s52, 14
    v_add_u32 v17, s28, v17
    v_xor_b32 v18, 0, v16
    v_lshl_add_u32 v8, v18, 4, v17
    v_xor_b32_e64 v18, 1, v16
    v_lshl_add_u32 v9, v18, 4, v17
    v_xor_b32_e64 v18, 4, v16
    v_lshl_add_u32 v10, v18, 4, v17
    v_xor_b32_e64 v18, 5, v16
    v_lshl_add_u32 v11, v18, 4, v17
    v_lshlrev_b32_e64 v12, 4, v2
    s_mov_b32 s40, 0xc0135761
    s_mov_b32 s41, 0xbdd2d3e8
    v_mov_b32_e64 v14, s40
    s_mul_i32 s30, s43, 28672
    s_lshl_b32 s28, s52, 12
    s_add_u32 s30, s30, s28
    s_mov_b32 s55, -98304
    s_mov_b32 s56, 16384
    s_mov_b32 s57, -24576
    s_movk_i32 s58, 4096
    s_mul_i32 s31, s43, 114688
    s_lshl_b32 s28, s38, 12
    s_add_u32 s31, s31, s28
    s_lshl_b32 s27, s43, 5
    s_add_u32 s27, s27, s38
    s_lshl_b32 s27, s27, 7
    s_add_u32 s27, s27, 131072
    s_lshl_b32 s43, s21, 3
    s_add_u32 s43, s43, s39
    s_mul_i32 s59, s36, 7
    s_lshr_b32 s28, s59, 1
    s_lshl_b32 s26, s43, 5
    s_add_u32 s26, s26, s28
    s_lshl_b32 s26, s26, 7
    s_add_u32 s26, s26, 131072
    s_mul_i32 s32, s43, 114688
    s_lshl_b32 s59, s59, 11
    s_add_u32 s32, s32, s59
    s_add_u32 s16, s6, 2097152
    s_addc_u32 s17, s7, 0
    s_mov_b32 s18, 1835008
    s_mov_b32 s19, 0x00020000
    s_add_u32 s48, s6, 6291456
    s_addc_u32 s49, s7, 0
    s_mov_b32 s50, 7340032
    s_mov_b32 s51, 0x00020000
    s_waitcnt vmcnt(0)
    s_mov_b32 s33, 0
    s_branch PC_h2
PL_h2:
    buffer_load_dword v15, v13, s[12:15], s29 offen sc1
    s_add_u32 s33, s33, 1
    s_waitcnt vmcnt(0)
PC_h2:
    v_cmp_ne_u32 vcc, s100, v15
    s_nop 0
    s_cbranch_vccz PD_h2
    s_mov_b64 exec, vcc
    s_cmp_lt_u32 s33, 200000
    s_cbranch_scc1 PL_h2
PD_h2:
    s_mov_b64 exec, -1
    s_cmp_lt_u32 s36, 4
    s_cbranch_scc1 KB_nr
    s_lshl_b32 s28, s20, 2
    s_add_u32 s28, s28, 139392
    v_mov_b32 v16, s28
    ds_write_b32 v16, v16
KB_nr:
    buffer_load_dwordx4 v[112:115], v12, s[16:19], s30 offen offset:0 sc1
    buffer_load_dwordx4 v[116:119], v12, s[16:19], s30 offen offset:1024 sc1
    buffer_load_dwordx4 v[120:123], v12, s[16:19], s30 offen offset:2048 sc1
    buffer_load_dwordx4 v[124:127], v12, s[16:19], s30 offen offset:3072 sc1
    s_add_u32 s30, s30, 4096
    buffer_load_dwordx4 v[128:131], v12, s[16:19], s30 offen offset:0 sc1
    buffer_load_dwordx4 v[132:135], v12, s[16:19], s30 offen offset:1024 sc1
    buffer_load_dwordx4 v[136:139], v12, s[16:19], s30 offen offset:2048 sc1
    buffer_load_dwordx4 v[140:143], v12, s[16:19], s30 offen offset:3072 sc1
    s_add_u32 s30, s30, 4096
    s_setprio 1
    s_cmp_ge_u32 s36, 4
    s_cbranch_scc1 KB_noprio
    s_barrier
    s_setprio 2
KB_noprio:
    ds_read_b64_tr_b16 v[80:81], v8 offset:0
    ds_read_b64_tr_b16 v[82:83], v8 offset:512
    ds_read_b64_tr_b16 v[84:85], v9 offset:0
    ds_read_b64_tr_b16 v[86:87], v9 offset:512
    ds_read_b64_tr_b16 v[88:89], v10 offset:0
    ds_read_b64_tr_b16 v[90:91], v10 offset:512
    ds_read_b64_tr_b16 v[92:93], v11 offset:0
    ds_read_b64_tr_b16 v[94:95], v11 offset:512
    s_waitcnt vmcnt(7) lgkmcnt(4)
    v_mfma_f32_32x32x16_bf16 v[16:31], v[80:83], v[112:115], 0
    ds_read_b64_tr_b16 v[96:97], v8 offset:4096
    ds_read_b64_tr_b16 v[98:99], v8 offset:4608
    v_mfma_f32_32x32x16_bf16 v[32:47], v[84:87], v[112:115], 0
    ds_read_b64_tr_b16 v[100:101], v9 offset:4096
    ds_read_b64_tr_b16 v[102:103], v9 offset:4608
    s_waitcnt lgkmcnt(4)
    v_mfma_f32_32x32x16_bf16 v[48:63], v[88:91], v[112:115], 0
    ds_read_b64_tr_b16 v[104:105], v10 offset:4096
    ds_read_b64_tr_b16 v[106:107], v10 offset:4608
    v_mfma_f32_32x32x16_bf16 v[64:79], v[92:95], v[112:115], 0
    ds_read_b64_tr_b16 v[108:109], v11 offset:4096
    ds_read_b64_tr_b16 v[110:111], v11 offset:4608
    s_waitcnt vmcnt(6) lgkmcnt(4)
    v_mfma_f32_32x32x16_bf16 v[16:31], v[96:99], v[116:119], v[16:31]
    ds_read_b64_tr_b16 v[80:81], v8 offset:8192
    ds_read_b64_tr_b16 v[82:83], v8 offset:8704
    v_mfma_f32_32x32x16_bf16 v[32:47], v[100:103], v[116:119], v[32:47]
    ds_read_b64_tr_b16 v[84:85], v9 offset:8192
    ds_read_b64_tr_b16 v[86:87], v9 offset:8704
    s_waitcnt lgkmcnt(4)
    v_mfma_f32_32x32x16_bf16 v[48:63], v[104:107], v[116:119], v[48:63]
    ds_read_b64_tr_b16 v[88:89], v10 offset:8192
    ds_read_b64_tr_b16 v[90:91], v10 offset:8704
    buffer_load_dwordx4 v[112:115], v12, s[16:19], s30 offen offset:0 sc1
    v_mfma_f32_32x32x16_bf16 v[64:79], v[108:111], v[116:119], v[64:79]
    ds_read_b64_tr_b16 v[92:93], v11 offset:8192
    ds_read_b64_tr_b16 v[94:95], v11 offset:8704
    s_waitcnt vmcnt(6) lgkmcnt(4)
    v_mfma_f32_32x32x16_bf16 v[16:31], v[80:83], v[120:123], v[16:31]
    ds_read_b64_tr_b16 v[96:97], v8 offset:12288
    ds_read_b64_tr_b16 v[98:99], v8 offset:12800
    v_mfma_f32_32x32x16_bf16 v[32:47], v[84:87], v[120:123], v[32:47]
    ds_read_b64_tr_b16 v[100:101], v9 offset:12288
    ds_read_b64_tr_b16 v[102:103], v9 offset:12800
    s_waitcnt lgkmcnt(4)
    v_mfma_f32_32x32x16_bf16 v[48:63], v[88:91], v[120:123], v[48:63]
    ds_read_b64_tr_b16 v[104:105], v10 offset:12288
    ds_read_b64_tr_b16 v[106:107], v10 offset:12800
    buffer_load_dwordx4 v[116:119], v12, s[16:19], s30 offen offset:1024 sc1
    v_mfma_f32_32x32x16_bf16 v[64:79], v[92:95], v[120:123], v[64:79]
    ds_read_b64_tr_b16 v[108:109], v11 offset:12288
    ds_read_b64_tr_b16 v[110:111], v11 offset:12800
    s_waitcnt vmcnt(6) lgkmcnt(4)
    v_mfma_f32_32x32x16_bf16 v[16:31], v[96:99], v[124:127], v[16:31]
    ds_read_b64_tr_b16 v[80:81], v8 offset:16384
    ds_read_b64_tr_b16 v[82:83], v8 offset:16896
    v_mfma_f32_32x32x16_bf16 v[32:47], v[100:103], v[124:127], v[32:47]
    ds_read_b64_tr_b16 v[84:85], v9 offset:16384
    ds_read_b64_tr_b16 v[86:87], v9 offset:16896
    s_waitcnt lgkmcnt(4)
    v_mfma_f32_32x32x16_bf16 v[48:63], v[104:107], v[124:127], v[48:63]
    ds_read_b64_tr_b16 v[88:89], v10 offset:16384
    ds_read_b64_tr_b16 v[90:91], v10 offset:16896
    buffer_load_dwordx4 v[120:123], v12, s[16:19], s30 offen offset:2048 sc1
    v_mfma_f32_32x32x16_bf16 v[64:79], v[108:111], v[124:127], v[64:79]
    ds_read_b64_tr_b16 v[92:93], v11 offset:16384
    ds_read_b64_tr_b16 v[94:95], v11 offset:16896
    s_waitcnt vmcnt(6) lgkmcnt(4)
    v_mfma_f32_32x32x16_bf16 v[16:31], v[80:83], v[128:131], v[16:31]
    ds_read_b64_tr_b16 v[96:97], v8 offset:20480
    ds_read_b64_tr_b16 v[98:99], v8 offset:20992
    v_mfma_f32_32x32x16_bf16 v[32:47], v[84:87], v[128:131], v[32:47]
    ds_read_b64_tr_b16 v[100:101], v9 offset:20480
    ds_read_b64_tr_b16 v[102:103], v9 offset:20992
    s_waitcnt lgkmcnt(4)
    v_mfma_f32_32x32x16_bf16 v[48:63], v[88:91], v[128:131], v[48:63]
    ds_read_b64_tr_b16 v[104:105], v10 offset:20480
    ds_read_b64_tr_b16 v[106:107], v10 offset:20992
    buffer_load_dwordx4 v[124:127], v12, s[16:19], s30 offen offset:3072 sc1
    s_add_u32 s30, s30, 4096
    v_mfma_f32_32x32x16_bf16 v[64:79], v[92:95], v[128:131], v[64:79]
    ds_read_b64_tr_b16 v[108:109], v11 offset:20480
    ds_read_b64_tr_b16 v[110:111], v11 offset:20992
    s_waitcnt vmcnt(6) lgkmcnt(4)
    v_mfma_f32_32x32x16_bf16 v[16:31], v[96:99], v[132:135], v[16:31]
    ds_read_b64_tr_b16 v[80:81], v8 offset:24576
    ds_read_b64_tr_b16 v[82:83], v8 offset:25088
    v_mfma_f32_32x32x16_bf16 v[32:47], v[100:103], v[132:135], v[32:47]
    ds_read_b64_tr_b16 v[84:85], v9 offset:24576
    ds_read_b64_tr_b16 v[86:87], v9 offset:25088
    s_waitcnt lgkmcnt(4)
    v_mfma_f32_32x32x16_bf16 v[48:63], v[104:107], v[132:135], v[48:63]
    ds_read_b64_tr_b16 v[88:89], v10 offset:24576
    ds_read_b64_tr_b16 v[90:91], v10 offset:25088
    buffer_load_dwordx4 v[128:131], v12, s[16:19], s30 offen offset:0 sc1
    v_mfma_f32_32x32x16_bf16 v[64:79], v[108:111], v[132:135], v[64:79]
    ds_read_b64_tr_b16 v[92:93], v11 offset:24576
    ds_read_b64_tr_b16 v[94:95], v11 offset:25088
    s_waitcnt vmcnt(6) lgkmcnt(4)
    v_mfma_f32_32x32x16_bf16 v[16:31], v[80:83], v[136:139], v[16:31]
    ds_read_b64_tr_b16 v[96:97], v8 offset:28672
    ds_read_b64_tr_b16 v[98:99], v8 offset:29184
    v_mfma_f32_32x32x16_bf16 v[32:47], v[84:87], v[136:139], v[32:47]
    ds_read_b64_tr_b16 v[100:101], v9 offset:28672
    ds_read_b64_tr_b16 v[102:103], v9 offset:29184
    s_waitcnt lgkmcnt(4)
    v_mfma_f32_32x32x16_bf16 v[48:63], v[88:91], v[136:139], v[48:63]
    ds_read_b64_tr_b16 v[104:105], v10 offset:28672
    ds_read_b64_tr_b16 v[106:107], v10 offset:29184
    buffer_load_dwordx4 v[132:135], v12, s[16:19], s30 offen offset:1024 sc1
    v_mfma_f32_32x32x16_bf16 v[64:79], v[92:95], v[136:139], v[64:79]
    ds_read_b64_tr_b16 v[108:109], v11 offset:28672
    ds_read_b64_tr_b16 v[110:111], v11 offset:29184
    s_waitcnt vmcnt(6) lgkmcnt(4)
    v_mfma_f32_32x32x16_bf16 v[16:31], v[96:99], v[140:143], v[16:31]
    ds_read_b64_tr_b16 v[80:81], v8 offset:32768
    ds_read_b64_tr_b16 v[82:83], v8 offset:33280
    v_mfma_f32_32x32x16_bf16 v[32:47], v[100:103], v[140:143], v[32:47]
    ds_read_b64_tr_b16 v[84:85], v9 offset:32768
    ds_read_b64_tr_b16 v[86:87], v9 offset:33280
    s_waitcnt lgkmcnt(4)
    v_mfma_f32_32x32x16_bf16 v[48:63], v[104:107], v[140:143], v[48:63]
    ds_read_b64_tr_b16 v[88:89], v10 offset:32768
    ds_read_b64_tr_b16 v[90:91], v10 offset:33280
    buffer_load_dwordx4 v[136:139], v12, s[16:19], s30 offen offset:2048 sc1
    v_mfma_f32_32x32x16_bf16 v[64:79], v[108:111], v[140:143], v[64:79]
    ds_read_b64_tr_b16 v[92:93], v11 offset:32768
    ds_read_b64_tr_b16 v[94:95], v11 offset:33280
    s_waitcnt vmcnt(6) lgkmcnt(4)
    v_mfma_f32_32x32x16_bf16 v[16:31], v[80:83], v[112:115], v[16:31]
    ds_read_b64_tr_b16 v[96:97], v8 offset:36864
    ds_read_b64_tr_b16 v[98:99], v8 offset:37376
    v_mfma_f32_32x32x16_bf16 v[32:47], v[84:87], v[112:115], v[32:47]
    ds_read_b64_tr_b16 v[100:101], v9 offset:36864
    ds_read_b64_tr_b16 v[102:103], v9 offset:37376
    s_waitcnt lgkmcnt(4)
    v_mfma_f32_32x32x16_bf16 v[48:63], v[88:91], v[112:115], v[48:63]
    ds_read_b64_tr_b16 v[104:105], v10 offset:36864
    ds_read_b64_tr_b16 v[106:107], v10 offset:37376
    buffer_load_dwordx4 v[140:143], v12, s[16:19], s30 offen offset:3072 sc1
    s_add_u32 s30, s30, 4096
    v_mfma_f32_32x32x16_bf16 v[64:79], v[92:95], v[112:115], v[64:79]
    ds_read_b64_tr_b16 v[108:109], v11 offset:36864
    ds_read_b64_tr_b16 v[110:111], v11 offset:37376
    s_waitcnt vmcnt(6) lgkmcnt(4)
    v_mfma_f32_32x32x16_bf16 v[16:31], v[96:99], v[116:119], v[16:31]
    ds_read_b64_tr_b16 v[80:81], v8 offset:40960
    ds_read_b64_tr_b16 v[82:83], v8 offset:41472
    v_mfma_f32_32x32x16_bf16 v[32:47], v[100:103], v[116:119], v[32:47]
    ds_read_b64_tr_b16 v[84:85], v9 offset:40960
    ds_read_b64_tr_b16 v[86:87], v9 offset:41472
    s_waitcnt lgkmcnt(4)
    v_mfma_f32_32x32x16_bf16 v[48:63], v[104:107], v[116:119], v[48:63]
    ds_read_b64_tr_b16 v[88:89], v10 offset:40960
    ds_read_b64_tr_b16 v[90:91], v10 offset:41472
    buffer_load_dwordx4 v[112:115], v12, s[16:19], s30 offen offset:0 sc1
    v_mfma_f32_32x32x16_bf16 v[64:79], v[108:111], v[116:119], v[64:79]
    ds_read_b64_tr_b16 v[92:93], v11 offset:40960
    ds_read_b64_tr_b16 v[94:95], v11 offset:41472
    s_waitcnt vmcnt(6) lgkmcnt(4)
    v_mfma_f32_32x32x16_bf16 v[16:31], v[80:83], v[120:123], v[16:31]
    ds_read_b64_tr_b16 v[96:97], v8 offset:45056
    ds_read_b64_tr_b16 v[98:99], v8 offset:45568
    v_mfma_f32_32x32x16_bf16 v[32:47], v[84:87], v[120:123], v[32:47]
    ds_read_b64_tr_b16 v[100:101], v9 offset:45056
    ds_read_b64_tr_b16 v[102:103], v9 offset:45568
    s_waitcnt lgkmcnt(4)
    v_mfma_f32_32x32x16_bf16 v[48:63], v[88:91], v[120:123], v[48:63]
    ds_read_b64_tr_b16 v[104:105], v10 offset:45056
    ds_read_b64_tr_b16 v[106:107], v10 offset:45568
    buffer_load_dwordx4 v[116:119], v12, s[16:19], s30 offen offset:1024 sc1
    v_mfma_f32_32x32x16_bf16 v[64:79], v[92:95], v[120:123], v[64:79]
    ds_read_b64_tr_b16 v[108:109], v11 offset:45056
    ds_read_b64_tr_b16 v[110:111], v11 offset:45568
    s_waitcnt vmcnt(6) lgkmcnt(4)
    v_mfma_f32_32x32x16_bf16 v[16:31], v[96:99], v[124:127], v[16:31]
    ds_read_b64_tr_b16 v[80:81], v8 offset:49152
    ds_read_b64_tr_b16 v[82:83], v8 offset:49664
    v_mfma_f32_32x32x16_bf16 v[32:47], v[100:103], v[124:127], v[32:47]
    ds_read_b64_tr_b16 v[84:85], v9 offset:49152
    ds_read_b64_tr_b16 v[86:87], v9 offset:49664
    s_waitcnt lgkmcnt(4)
    v_mfma_f32_32x32x16_bf16 v[48:63], v[104:107], v[124:127], v[48:63]
    ds_read_b64_tr_b16 v[88:89], v10 offset:49152
    ds_read_b64_tr_b16 v[90:91], v10 offset:49664
    buffer_load_dwordx4 v[120:123], v12, s[16:19], s30 offen offset:2048 sc1
    v_mfma_f32_32x32x16_bf16 v[64:79], v[108:111], v[124:127], v[64:79]
    ds_read_b64_tr_b16 v[92:93], v11 offset:49152
    ds_read_b64_tr_b16 v[94:95], v11 offset:49664
    s_waitcnt vmcnt(6) lgkmcnt(4)
    v_mfma_f32_32x32x16_bf16 v[16:31], v[80:83], v[128:131], v[16:31]
    ds_read_b64_tr_b16 v[96:97], v8 offset:53248
    ds_read_b64_tr_b16 v[98:99], v8 offset:53760
    v_mfma_f32_32x32x16_bf16 v[32:47], v[84:87], v[128:131], v[32:47]
    ds_read_b64_tr_b16 v[100:101], v9 offset:53248
    ds_read_b64_tr_b16 v[102:103], v9 offset:53760
    s_waitcnt lgkmcnt(4)
    v_mfma_f32_32x32x16_bf16 v[48:63], v[88:91], v[128:131], v[48:63]
    ds_read_b64_tr_b16 v[104:105], v10 offset:53248
    ds_read_b64_tr_b16 v[106:107], v10 offset:53760
    buffer_load_dwordx4 v[124:127], v12, s[16:19], s30 offen offset:3072 sc1
    s_add_u32 s30, s30, 4096
    v_mfma_f32_32x32x16_bf16 v[64:79], v[92:95], v[128:131], v[64:79]
    ds_read_b64_tr_b16 v[108:109], v11 offset:53248
    ds_read_b64_tr_b16 v[110:111], v11 offset:53760
    s_mov_b32 s54, 57344
    s_waitcnt vmcnt(6) lgkmcnt(4)
    v_mfma_f32_32x32x16_bf16 v[16:31], v[96:99], v[132:135], v[16:31]
    v_add_u32_e64 v8, s54, v8
    ds_read_b64_tr_b16 v[80:81], v8 offset:0
    ds_read_b64_tr_b16 v[82:83], v8 offset:512
    v_mfma_f32_32x32x16_bf16 v[32:47], v[100:103], v[132:135], v[32:47]
    v_add_u32_e64 v9, s54, v9
    ds_read_b64_tr_b16 v[84:85], v9 offset:0
    ds_read_b64_tr_b16 v[86:87], v9 offset:512
    s_waitcnt lgkmcnt(4)
    v_mfma_f32_32x32x16_bf16 v[48:63], v[104:107], v[132:135], v[48:63]
    v_add_u32 v10, s54, v10
    ds_read_b64_tr_b16 v[88:89], v10 offset:0
    ds_read_b64_tr_b16 v[90:91], v10 offset:512
    buffer_load_dwordx4 v[128:131], v12, s[16:19], s30 offen offset:0 sc1
    v_mfma_f32_32x32x16_bf16 v[64:79], v[108:111], v[132:135], v[64:79]
    v_add_u32_e64 v11, s54, v11
    ds_read_b64_tr_b16 v[92:93], v11 offset:0
    ds_read_b64_tr_b16 v[94:95], v11 offset:512
    s_waitcnt vmcnt(6) lgkmcnt(4)
    v_mfma_f32_32x32x16_bf16 v[16:31], v[80:83], v[136:139], v[16:31]
    ds_read_b64_tr_b16 v[96:97], v8 offset:4096
    ds_read_b64_tr_b16 v[98:99], v8 offset:4608
    v_mfma_f32_32x32x16_bf16 v[32:47], v[84:87], v[136:139], v[32:47]
    ds_read_b64_tr_b16 v[100:101], v9 offset:4096
    ds_read_b64_tr_b16 v[102:103], v9 offset:4608
    s_waitcnt lgkmcnt(4)
    v_mfma_f32_32x32x16_bf16 v[48:63], v[88:91], v[136:139], v[48:63]
    ds_read_b64_tr_b16 v[104:105], v10 offset:4096
    ds_read_b64_tr_b16 v[106:107], v10 offset:4608
    buffer_load_dwordx4 v[132:135], v12, s[16:19], s30 offen offset:1024 sc1
    v_mfma_f32_32x32x16_bf16 v[64:79], v[92:95], v[136:139], v[64:79]
    ds_read_b64_tr_b16 v[108:109], v11 offset:4096
    ds_read_b64_tr_b16 v[110:111], v11 offset:4608
    s_waitcnt vmcnt(6) lgkmcnt(4)
    v_mfma_f32_32x32x16_bf16 v[16:31], v[96:99], v[140:143], v[16:31]
    ds_read_b64_tr_b16 v[80:81], v8 offset:8192
    ds_read_b64_tr_b16 v[82:83], v8 offset:8704
    v_mfma_f32_32x32x16_bf16 v[32:47], v[100:103], v[140:143], v[32:47]
    ds_read_b64_tr_b16 v[84:85], v9 offset:8192
    ds_read_b64_tr_b16 v[86:87], v9 offset:8704
    s_waitcnt lgkmcnt(4)
    v_mfma_f32_32x32x16_bf16 v[48:63], v[104:107], v[140:143], v[48:63]
    ds_read_b64_tr_b16 v[88:89], v10 offset:8192
    ds_read_b64_tr_b16 v[90:91], v10 offset:8704
    buffer_load_dwordx4 v[136:139], v12, s[16:19], s30 offen offset:2048 sc1
    v_mfma_f32_32x32x16_bf16 v[64:79], v[108:111], v[140:143], v[64:79]
    ds_read_b64_tr_b16 v[92:93], v11 offset:8192
    ds_read_b64_tr_b16 v[94:95], v11 offset:8704
    s_waitcnt vmcnt(6) lgkmcnt(4)
    v_mfma_f32_32x32x16_bf16 v[16:31], v[80:83], v[112:115], v[16:31]
    ds_read_b64_tr_b16 v[96:97], v8 offset:12288
    ds_read_b64_tr_b16 v[98:99], v8 offset:12800
    v_mfma_f32_32x32x16_bf16 v[32:47], v[84:87], v[112:115], v[32:47]
    ds_read_b64_tr_b16 v[100:101], v9 offset:12288
    ds_read_b64_tr_b16 v[102:103], v9 offset:12800
    s_waitcnt lgkmcnt(4)
    v_mfma_f32_32x32x16_bf16 v[48:63], v[88:91], v[112:115], v[48:63]
    ds_read_b64_tr_b16 v[104:105], v10 offset:12288
    ds_read_b64_tr_b16 v[106:107], v10 offset:12800
    buffer_load_dwordx4 v[140:143], v12, s[16:19], s30 offen offset:3072 sc1
    s_add_u32 s30, s30, 4096
    v_mfma_f32_32x32x16_bf16 v[64:79], v[92:95], v[112:115], v[64:79]
    ds_read_b64_tr_b16 v[108:109], v11 offset:12288
    ds_read_b64_tr_b16 v[110:111], v11 offset:12800
    s_waitcnt vmcnt(6) lgkmcnt(4)
    v_mfma_f32_32x32x16_bf16 v[16:31], v[96:99], v[116:119], v[16:31]
    ds_read_b64_tr_b16 v[80:81], v8 offset:16384
    ds_read_b64_tr_b16 v[82:83], v8 offset:16896
    v_mfma_f32_32x32x16_bf16 v[32:47], v[100:103], v[116:119], v[32:47]
    ds_read_b64_tr_b16 v[84:85], v9 offset:16384
    ds_read_b64_tr_b16 v[86:87], v9 offset:16896
    s_waitcnt lgkmcnt(4)
    v_mfma_f32_32x32x16_bf16 v[48:63], v[104:107], v[116:119], v[48:63]
    ds_read_b64_tr_b16 v[88:89], v10 offset:16384
    ds_read_b64_tr_b16 v[90:91], v10 offset:16896
    buffer_load_dwordx4 v[112:115], v12, s[16:19], s30 offen offset:0 sc1
    v_mfma_f32_32x32x16_bf16 v[64:79], v[108:111], v[116:119], v[64:79]
    ds_read_b64_tr_b16 v[92:93], v11 offset:16384
    ds_read_b64_tr_b16 v[94:95], v11 offset:16896
    s_waitcnt vmcnt(6) lgkmcnt(4)
    v_mfma_f32_32x32x16_bf16 v[16:31], v[80:83], v[120:123], v[16:31]
    ds_read_b64_tr_b16 v[96:97], v8 offset:20480
    ds_read_b64_tr_b16 v[98:99], v8 offset:20992
    v_mfma_f32_32x32x16_bf16 v[32:47], v[84:87], v[120:123], v[32:47]
    ds_read_b64_tr_b16 v[100:101], v9 offset:20480
    ds_read_b64_tr_b16 v[102:103], v9 offset:20992
    s_waitcnt lgkmcnt(4)
    v_mfma_f32_32x32x16_bf16 v[48:63], v[88:91], v[120:123], v[48:63]
    ds_read_b64_tr_b16 v[104:105], v10 offset:20480
    ds_read_b64_tr_b16 v[106:107], v10 offset:20992
    buffer_load_dwordx4 v[116:119], v12, s[16:19], s30 offen offset:1024 sc1
    v_mfma_f32_32x32x16_bf16 v[64:79], v[92:95], v[120:123], v[64:79]
    ds_read_b64_tr_b16 v[108:109], v11 offset:20480
    ds_read_b64_tr_b16 v[110:111], v11 offset:20992
    s_waitcnt vmcnt(6) lgkmcnt(4)
    v_mfma_f32_32x32x16_bf16 v[16:31], v[96:99], v[124:127], v[16:31]
    ds_read_b64_tr_b16 v[80:81], v8 offset:24576
    ds_read_b64_tr_b16 v[82:83], v8 offset:25088
    v_mfma_f32_32x32x16_bf16 v[32:47], v[100:103], v[124:127], v[32:47]
    ds_read_b64_tr_b16 v[84:85], v9 offset:24576
    ds_read_b64_tr_b16 v[86:87], v9 offset:25088
    s_waitcnt lgkmcnt(4)
    v_mfma_f32_32x32x16_bf16 v[48:63], v[104:107], v[124:127], v[48:63]
    ds_read_b64_tr_b16 v[88:89], v10 offset:24576
    ds_read_b64_tr_b16 v[90:91], v10 offset:25088
    buffer_load_dwordx4 v[120:123], v12, s[16:19], s30 offen offset:2048 sc1
    v_mfma_f32_32x32x16_bf16 v[64:79], v[108:111], v[124:127], v[64:79]
    ds_read_b64_tr_b16 v[92:93], v11 offset:24576
    ds_read_b64_tr_b16 v[94:95], v11 offset:25088
    s_waitcnt vmcnt(6) lgkmcnt(4)
    v_mfma_f32_32x32x16_bf16 v[16:31], v[80:83], v[128:131], v[16:31]
    ds_read_b64_tr_b16 v[96:97], v8 offset:28672
    ds_read_b64_tr_b16 v[98:99], v8 offset:29184
    v_mfma_f32_32x32x16_bf16 v[32:47], v[84:87], v[128:131], v[32:47]
    ds_read_b64_tr_b16 v[100:101], v9 offset:28672
    ds_read_b64_tr_b16 v[102:103], v9 offset:29184
    s_waitcnt lgkmcnt(4)
    v_mfma_f32_32x32x16_bf16 v[48:63], v[88:91], v[128:131], v[48:63]
    ds_read_b64_tr_b16 v[104:105], v10 offset:28672
    ds_read_b64_tr_b16 v[106:107], v10 offset:29184
    buffer_load_dwordx4 v[124:127], v12, s[16:19], s30 offen offset:3072 sc1
    v_mfma_f32_32x32x16_bf16 v[64:79], v[92:95], v[128:131], v[64:79]
    ds_read_b64_tr_b16 v[108:109], v11 offset:28672
    ds_read_b64_tr_b16 v[110:111], v11 offset:29184
    s_waitcnt vmcnt(6) lgkmcnt(4)
    v_mfma_f32_32x32x16_bf16 v[16:31], v[96:99], v[132:135], v[16:31]
    ds_read_b64_tr_b16 v[80:81], v8 offset:32768
    ds_read_b64_tr_b16 v[82:83], v8 offset:33280
    v_mfma_f32_32x32x16_bf16 v[32:47], v[100:103], v[132:135], v[32:47]
    ds_read_b64_tr_b16 v[84:85], v9 offset:32768
    ds_read_b64_tr_b16 v[86:87], v9 offset:33280
    s_waitcnt lgkmcnt(4)
    v_mfma_f32_32x32x16_bf16 v[48:63], v[104:107], v[132:135], v[48:63]
    ds_read_b64_tr_b16 v[88:89], v10 offset:32768
    ds_read_b64_tr_b16 v[90:91], v10 offset:33280
    v_mfma_f32_32x32x16_bf16 v[64:79], v[108:111], v[132:135], v[64:79]
    ds_read_b64_tr_b16 v[92:93], v11 offset:32768
    ds_read_b64_tr_b16 v[94:95], v11 offset:33280
    s_waitcnt vmcnt(5) lgkmcnt(4)
    v_mfma_f32_32x32x16_bf16 v[16:31], v[80:83], v[136:139], v[16:31]
    ds_read_b64_tr_b16 v[96:97], v8 offset:36864
    ds_read_b64_tr_b16 v[98:99], v8 offset:37376
    v_mfma_f32_32x32x16_bf16 v[32:47], v[84:87], v[136:139], v[32:47]
    ds_read_b64_tr_b16 v[100:101], v9 offset:36864
    ds_read_b64_tr_b16 v[102:103], v9 offset:37376
    s_waitcnt lgkmcnt(4)
    v_mfma_f32_32x32x16_bf16 v[48:63], v[88:91], v[136:139], v[48:63]
    ds_read_b64_tr_b16 v[104:105], v10 offset:36864
    ds_read_b64_tr_b16 v[106:107], v10 offset:37376
    v_mfma_f32_32x32x16_bf16 v[64:79], v[92:95], v[136:139], v[64:79]
    ds_read_b64_tr_b16 v[108:109], v11 offset:36864
    ds_read_b64_tr_b16 v[110:111], v11 offset:37376
    s_waitcnt vmcnt(4) lgkmcnt(4)
    v_mfma_f32_32x32x16_bf16 v[16:31], v[96:99], v[140:143], v[16:31]
    ds_read_b64_tr_b16 v[80:81], v8 offset:40960
    ds_read_b64_tr_b16 v[82:83], v8 offset:41472
    v_mfma_f32_32x32x16_bf16 v[32:47], v[100:103], v[140:143], v[32:47]
    ds_read_b64_tr_b16 v[84:85], v9 offset:40960
    ds_read_b64_tr_b16 v[86:87], v9 offset:41472
    s_waitcnt lgkmcnt(4)
    v_mfma_f32_32x32x16_bf16 v[48:63], v[104:107], v[140:143], v[48:63]
    ds_read_b64_tr_b16 v[88:89], v10 offset:40960
    ds_read_b64_tr_b16 v[90:91], v10 offset:41472
    v_mfma_f32_32x32x16_bf16 v[64:79], v[108:111], v[140:143], v[64:79]
    ds_read_b64_tr_b16 v[92:93], v11 offset:40960
    ds_read_b64_tr_b16 v[94:95], v11 offset:41472
    s_waitcnt vmcnt(3) lgkmcnt(4)
    v_mfma_f32_32x32x16_bf16 v[16:31], v[80:83], v[112:115], v[16:31]
    ds_read_b64_tr_b16 v[96:97], v8 offset:45056
    ds_read_b64_tr_b16 v[98:99], v8 offset:45568
    v_mfma_f32_32x32x16_bf16 v[32:47], v[84:87], v[112:115], v[32:47]
    ds_read_b64_tr_b16 v[100:101], v9 offset:45056
    ds_read_b64_tr_b16 v[102:103], v9 offset:45568
    s_waitcnt lgkmcnt(4)
    v_mfma_f32_32x32x16_bf16 v[48:63], v[88:91], v[112:115], v[48:63]
    ds_read_b64_tr_b16 v[104:105], v10 offset:45056
    ds_read_b64_tr_b16 v[106:107], v10 offset:45568
    v_mfma_f32_32x32x16_bf16 v[64:79], v[92:95], v[112:115], v[64:79]
    ds_read_b64_tr_b16 v[108:109], v11 offset:45056
    ds_read_b64_tr_b16 v[110:111], v11 offset:45568
    s_waitcnt vmcnt(2) lgkmcnt(4)
    v_mfma_f32_32x32x16_bf16 v[16:31], v[96:99], v[116:119], v[16:31]
    ds_read_b64_tr_b16 v[80:81], v8 offset:49152
    ds_read_b64_tr_b16 v[82:83], v8 offset:49664
    v_mfma_f32_32x32x16_bf16 v[32:47], v[100:103], v[116:119], v[32:47]
    ds_read_b64_tr_b16 v[84:85], v9 offset:49152
    ds_read_b64_tr_b16 v[86:87], v9 offset:49664
    s_waitcnt lgkmcnt(4)
    v_mfma_f32_32x32x16_bf16 v[48:63], v[104:107], v[116:119], v[48:63]
    ds_read_b64_tr_b16 v[88:89], v10 offset:49152
    ds_read_b64_tr_b16 v[90:91], v10 offset:49664
    v_mfma_f32_32x32x16_bf16 v[64:79], v[108:111], v[116:119], v[64:79]
    ds_read_b64_tr_b16 v[92:93], v11 offset:49152
    ds_read_b64_tr_b16 v[94:95], v11 offset:49664
    s_waitcnt vmcnt(1) lgkmcnt(4)
    v_mfma_f32_32x32x16_bf16 v[16:31], v[80:83], v[120:123], v[16:31]
    ds_read_b64_tr_b16 v[96:97], v8 offset:53248
    ds_read_b64_tr_b16 v[98:99], v8 offset:53760
    v_mfma_f32_32x32x16_bf16 v[32:47], v[84:87], v[120:123], v[32:47]
    ds_read_b64_tr_b16 v[100:101], v9 offset:53248
    ds_read_b64_tr_b16 v[102:103], v9 offset:53760
    s_waitcnt lgkmcnt(4)
    v_mfma_f32_32x32x16_bf16 v[48:63], v[88:91], v[120:123], v[48:63]
    ds_read_b64_tr_b16 v[104:105], v10 offset:53248
    ds_read_b64_tr_b16 v[106:107], v10 offset:53760
    v_mfma_f32_32x32x16_bf16 v[64:79], v[92:95], v[120:123], v[64:79]
    ds_read_b64_tr_b16 v[108:109], v11 offset:53248
    ds_read_b64_tr_b16 v[110:111], v11 offset:53760
    s_waitcnt vmcnt(0) lgkmcnt(4)
    v_mfma_f32_32x32x16_bf16 v[16:31], v[96:99], v[124:127], v[16:31]
    v_mfma_f32_32x32x16_bf16 v[32:47], v[100:103], v[124:127], v[32:47]
    s_waitcnt lgkmcnt(0)
    v_mfma_f32_32x32x16_bf16 v[48:63], v[104:107], v[124:127], v[48:63]
    v_mfma_f32_32x32x16_bf16 v[64:79], v[108:111], v[124:127], v[64:79]
    s_cmp_ge_u32 s36, 4
    s_cbranch_scc1 KB_Bepi
    s_setprio 0
    v_mov_b32 v15, 0xbdd2d3e8
    s_nop 3
    v_mul_f32 v80, v16, v16
    v_mul_f32 v81, v17, v17
    v_mul_f32 v82, v18, v18
    v_mul_f32 v83, v19, v19
    v_mul_f32 v84, v20, v20
    v_mul_f32 v85, v21, v21
    v_mul_f32 v86, v22, v22
    v_mul_f32 v87, v23, v23
    v_fma_f32 v80, v80, v15, v14
    v_fma_f32 v81, v81, v15, v14
    v_fma_f32 v82, v82, v15, v14
    v_fma_f32 v83, v83, v15, v14
    v_fma_f32 v84, v84, v15, v14
    v_fma_f32 v85, v85, v15, v14
    v_fma_f32 v86, v86, v15, v14
    v_fma_f32 v87, v87, v15, v14
    v_mul_f32 v80, v80, v16
    v_mul_f32 v81, v81, v17
    v_mul_f32 v82, v82, v18
    v_mul_f32 v83, v83, v19
    v_mul_f32 v84, v84, v20
    v_mul_f32 v85, v85, v21
    v_mul_f32 v86, v86, v22
    v_mul_f32 v87, v87, v23
    v_exp_f32 v80, v80
    v_mul_f32 v24, v24, v16
    v_exp_f32 v81, v81
    v_mul_f32 v25, v25, v17
    v_exp_f32 v82, v82
    v_mul_f32 v26, v26, v18
    v_exp_f32 v83, v83
    v_mul_f32 v27, v27, v19
    v_exp_f32 v84, v84
    v_mul_f32 v28, v28, v20
    v_exp_f32 v85, v85
    v_mul_f32 v29, v29, v21
    v_exp_f32 v86, v86
    v_mul_f32 v30, v30, v22
    v_exp_f32 v87, v87
    v_mul_f32 v31, v31, v23
    v_add_f32 v80, 1.0, v80
    v_add_f32 v81, 1.0, v81
    v_add_f32 v82, 1.0, v82
    v_add_f32 v83, 1.0, v83
    v_add_f32 v84, 1.0, v84
    v_add_f32 v85, 1.0, v85
    v_add_f32 v86, 1.0, v86
    v_add_f32 v87, 1.0, v87
    v_rcp_f32 v80, v80
    v_rcp_f32 v81, v81
    v_rcp_f32 v82, v82
    v_rcp_f32 v83, v83
    v_rcp_f32 v84, v84
    v_rcp_f32 v85, v85
    v_rcp_f32 v86, v86
    v_rcp_f32 v87, v87
    v_mul_f32 v24, v24, v80
    v_mul_f32 v25, v25, v81
    v_mul_f32 v26, v26, v82
    v_mul_f32 v27, v27, v83
    v_mul_f32 v28, v28, v84
    v_mul_f32 v29, v29, v85
    v_mul_f32 v30, v30, v86
    v_mul_f32 v31, v31, v87
    v_cvt_pk_bf16_f32 v16, v24, v25
    v_cvt_pk_bf16_f32 v17, v26, v27
    v_cvt_pk_bf16_f32 v18, v28, v29
    v_cvt_pk_bf16_f32 v19, v30, v31
    buffer_store_dwordx4 v[16:19], v12, s[48:51], s31 offen offset:0 sc1
    v_mul_f32 v80, v32, v32
    v_mul_f32 v81, v33, v33
    v_mul_f32 v82, v34, v34
    v_mul_f32 v83, v35, v35
    v_mul_f32 v84, v36, v36
    v_mul_f32 v85, v37, v37
    v_mul_f32 v86, v38, v38
    v_mul_f32 v87, v39, v39
    v_fma_f32 v80, v80, v15, v14
    v_fma_f32 v81, v81, v15, v14
    v_fma_f32 v82, v82, v15, v14
    v_fma_f32 v83, v83, v15, v14
    v_fma_f32 v84, v84, v15, v14
    v_fma_f32 v85, v85, v15, v14
    v_fma_f32 v86, v86, v15, v14
    v_fma_f32 v87, v87, v15, v14
    v_mul_f32 v80, v80, v32
    v_mul_f32 v81, v81, v33
    v_mul_f32 v82, v82, v34
    v_mul_f32 v83, v83, v35
    v_mul_f32 v84, v84, v36
    v_mul_f32 v85, v85, v37
    v_mul_f32 v86, v86, v38
    v_mul_f32 v87, v87, v39
    v_exp_f32 v80, v80
    v_mul_f32 v40, v40, v32
    v_exp_f32 v81, v81
    v_mul_f32 v41, v41, v33
    v_exp_f32 v82, v82
    v_mul_f32 v42, v42, v34
    v_exp_f32 v83, v83
    v_mul_f32 v43, v43, v35
    v_exp_f32 v84, v84
    v_mul_f32 v44, v44, v36
    v_exp_f32 v85, v85
    v_mul_f32 v45, v45, v37
    v_exp_f32 v86, v86
    v_mul_f32 v46, v46, v38
    v_exp_f32 v87, v87
    v_mul_f32 v47, v47, v39
    v_add_f32 v80, 1.0, v80
    v_add_f32 v81, 1.0, v81
    v_add_f32 v82, 1.0, v82
    v_add_f32 v83, 1.0, v83
    v_add_f32 v84, 1.0, v84
    v_add_f32 v85, 1.0, v85
    v_add_f32 v86, 1.0, v86
    v_add_f32 v87, 1.0, v87
    v_rcp_f32 v80, v80
    v_rcp_f32 v81, v81
    v_rcp_f32 v82, v82
    v_rcp_f32 v83, v83
    v_rcp_f32 v84, v84
    v_rcp_f32 v85, v85
    v_rcp_f32 v86, v86
    v_rcp_f32 v87, v87
    v_mul_f32 v40, v40, v80
    v_mul_f32 v41, v41, v81
    v_mul_f32 v42, v42, v82
    v_mul_f32 v43, v43, v83
    v_mul_f32 v44, v44, v84
    v_mul_f32 v45, v45, v85
    v_mul_f32 v46, v46, v86
    v_mul_f32 v47, v47, v87
    v_cvt_pk_bf16_f32 v32, v40, v41
    v_cvt_pk_bf16_f32 v33, v42, v43
    v_cvt_pk_bf16_f32 v34, v44, v45
    v_cvt_pk_bf16_f32 v35, v46, v47
    buffer_store_dwordx4 v[32:35], v12, s[48:51], s31 offen offset:1024 sc1
    v_mul_f32 v80, v48, v48
    v_mul_f32 v81, v49, v49
    v_mul_f32 v82, v50, v50
    v_mul_f32 v83, v51, v51
    v_mul_f32 v84, v52, v52
    v_mul_f32 v85, v53, v53
    v_mul_f32 v86, v54, v54
    v_mul_f32 v87, v55, v55
    v_fma_f32 v80, v80, v15, v14
    v_fma_f32 v81, v81, v15, v14
    v_fma_f32 v82, v82, v15, v14
    v_fma_f32 v83, v83, v15, v14
    v_fma_f32 v84, v84, v15, v14
    v_fma_f32 v85, v85, v15, v14
    v_fma_f32 v86, v86, v15, v14
    v_fma_f32 v87, v87, v15, v14
    v_mul_f32 v80, v80, v48
    v_mul_f32 v81, v81, v49
    v_mul_f32 v82, v82, v50
    v_mul_f32 v83, v83, v51
    v_mul_f32 v84, v84, v52
    v_mul_f32 v85, v85, v53
    v_mul_f32 v86, v86, v54
    v_mul_f32 v87, v87, v55
    v_exp_f32 v80, v80
    v_mul_f32 v56, v56, v48
    v_exp_f32 v81, v81
    v_mul_f32 v57, v57, v49
    v_exp_f32 v82, v82
    v_mul_f32 v58, v58, v50
    v_exp_f32 v83, v83
    v_mul_f32 v59, v59, v51
    v_exp_f32 v84, v84
    v_mul_f32 v60, v60, v52
    v_exp_f32 v85, v85
    v_mul_f32 v61, v61, v53
    v_exp_f32 v86, v86
    v_mul_f32 v62, v62, v54
    v_exp_f32 v87, v87
    v_mul_f32 v63, v63, v55
    v_add_f32 v80, 1.0, v80
    v_add_f32 v81, 1.0, v81
    v_add_f32 v82, 1.0, v82
    v_add_f32 v83, 1.0, v83
    v_add_f32 v84, 1.0, v84
    v_add_f32 v85, 1.0, v85
    v_add_f32 v86, 1.0, v86
    v_add_f32 v87, 1.0, v87
    v_rcp_f32 v80, v80
    v_rcp_f32 v81, v81
    v_rcp_f32 v82, v82
    v_rcp_f32 v83, v83
    v_rcp_f32 v84, v84
    v_rcp_f32 v85, v85
    v_rcp_f32 v86, v86
    v_rcp_f32 v87, v87
    v_mul_f32 v56, v56, v80
    v_mul_f32 v57, v57, v81
    v_mul_f32 v58, v58, v82
    v_mul_f32 v59, v59, v83
    v_mul_f32 v60, v60, v84
    v_mul_f32 v61, v61, v85
    v_mul_f32 v62, v62, v86
    v_mul_f32 v63, v63, v87
    v_cvt_pk_bf16_f32 v48, v56, v57
    v_cvt_pk_bf16_f32 v49, v58, v59
    v_cvt_pk_bf16_f32 v50, v60, v61
    v_cvt_pk_bf16_f32 v51, v62, v63
    buffer_store_dwordx4 v[48:51], v12, s[48:51], s31 offen offset:2048 sc1
    v_mul_f32 v80, v64, v64
    v_mul_f32 v81, v65, v65
    v_mul_f32 v82, v66, v66
    v_mul_f32 v83, v67, v67
    v_mul_f32 v84, v68, v68
    v_mul_f32 v85, v69, v69
    v_mul_f32 v86, v70, v70
    v_mul_f32 v87, v71, v71
    v_fma_f32 v80, v80, v15, v14
    v_fma_f32 v81, v81, v15, v14
    v_fma_f32 v82, v82, v15, v14
    v_fma_f32 v83, v83, v15, v14
    v_fma_f32 v84, v84, v15, v14
    v_fma_f32 v85, v85, v15, v14
    v_fma_f32 v86, v86, v15, v14
    v_fma_f32 v87, v87, v15, v14
    v_mul_f32 v80, v80, v64
    v_mul_f32 v81, v81, v65
    v_mul_f32 v82, v82, v66
    v_mul_f32 v83, v83, v67
    v_mul_f32 v84, v84, v68
    v_mul_f32 v85, v85, v69
    v_mul_f32 v86, v86, v70
    v_mul_f32 v87, v87, v71
    v_exp_f32 v80, v80
    v_mul_f32 v72, v72, v64
    v_exp_f32 v81, v81
    v_mul_f32 v73, v73, v65
    v_exp_f32 v82, v82
    v_mul_f32 v74, v74, v66
    v_exp_f32 v83, v83
    v_mul_f32 v75, v75, v67
    v_exp_f32 v84, v84
    v_mul_f32 v76, v76, v68
    v_exp_f32 v85, v85
    v_mul_f32 v77, v77, v69
    v_exp_f32 v86, v86
    v_mul_f32 v78, v78, v70
    v_exp_f32 v87, v87
    v_mul_f32 v79, v79, v71
    v_add_f32 v80, 1.0, v80
    v_add_f32 v81, 1.0, v81
    v_add_f32 v82, 1.0, v82
    v_add_f32 v83, 1.0, v83
    v_add_f32 v84, 1.0, v84
    v_add_f32 v85, 1.0, v85
    v_add_f32 v86, 1.0, v86
    v_add_f32 v87, 1.0, v87
    v_rcp_f32 v80, v80
    v_rcp_f32 v81, v81
    v_rcp_f32 v82, v82
    v_rcp_f32 v83, v83
    v_rcp_f32 v84, v84
    v_rcp_f32 v85, v85
    v_rcp_f32 v86, v86
    v_rcp_f32 v87, v87
    v_mul_f32 v72, v72, v80
    v_mul_f32 v73, v73, v81
    v_mul_f32 v74, v74, v82
    v_mul_f32 v75, v75, v83
    v_mul_f32 v76, v76, v84
    v_mul_f32 v77, v77, v85
    v_mul_f32 v78, v78, v86
    v_mul_f32 v79, v79, v87
    v_cvt_pk_bf16_f32 v64, v72, v73
    v_cvt_pk_bf16_f32 v65, v74, v75
    v_cvt_pk_bf16_f32 v66, v76, v77
    v_cvt_pk_bf16_f32 v67, v78, v79
    buffer_store_dwordx4 v[64:67], v12, s[48:51], s31 offen offset:3072 sc1
    s_setprio 0
    s_branch KB_E
KB_Bepi:
    s_setprio 3
    s_nop 7
    s_nop 3
    s_nop 0
    v_pk_mul_f32 v[80:81], v[16:17], v[16:17]
    v_pk_mul_f32 v[82:83], v[18:19], v[18:19]
    v_pk_mul_f32 v[84:85], v[20:21], v[20:21]
    v_pk_mul_f32 v[86:87], v[22:23], v[22:23]
    v_pk_fma_f32 v[80:81], v[80:81], s[40:41], v[14:15] op_sel:[0,1,0] op_sel_hi:[1,1,0]
    v_pk_fma_f32 v[82:83], v[82:83], s[40:41], v[14:15] op_sel:[0,1,0] op_sel_hi:[1,1,0]
    v_pk_fma_f32 v[84:85], v[84:85], s[40:41], v[14:15] op_sel:[0,1,0] op_sel_hi:[1,1,0]
    v_pk_fma_f32 v[86:87], v[86:87], s[40:41], v[14:15] op_sel:[0,1,0] op_sel_hi:[1,1,0]
    v_pk_mul_f32 v[80:81], v[80:81], v[16:17]
    v_pk_mul_f32 v[82:83], v[82:83], v[18:19]
    v_pk_mul_f32 v[84:85], v[84:85], v[20:21]
    v_pk_mul_f32 v[86:87], v[86:87], v[22:23]
    v_exp_f32 v80, v80
    v_exp_f32 v81, v81
    v_exp_f32 v82, v82
    v_exp_f32 v83, v83
    v_exp_f32 v84, v84
    v_exp_f32 v85, v85
    v_exp_f32 v86, v86
    v_exp_f32 v87, v87
    v_pk_add_f32 v[80:81], v[80:81], 1.0 op_sel_hi:[1,0]
    v_pk_add_f32 v[82:83], v[82:83], 1.0 op_sel_hi:[1,0]
    v_pk_add_f32 v[84:85], v[84:85], 1.0 op_sel_hi:[1,0]
    v_pk_add_f32 v[86:87], v[86:87], 1.0 op_sel_hi:[1,0]
    v_rcp_f32 v80, v80
    v_rcp_f32 v81, v81
    v_rcp_f32 v82, v82
    v_rcp_f32 v83, v83
    v_rcp_f32 v84, v84
    v_rcp_f32 v85, v85
    v_rcp_f32 v86, v86
    v_rcp_f32 v87, v87
    v_pk_mul_f32 v[24:25], v[24:25], v[16:17]
    v_pk_mul_f32 v[26:27], v[26:27], v[18:19]
    v_pk_mul_f32 v[28:29], v[28:29], v[20:21]
    v_pk_mul_f32 v[30:31], v[30:31], v[22:23]
    v_pk_mul_f32 v[24:25], v[24:25], v[80:81]
    v_pk_mul_f32 v[26:27], v[26:27], v[82:83]
    v_pk_mul_f32 v[28:29], v[28:29], v[84:85]
    v_pk_mul_f32 v[30:31], v[30:31], v[86:87]
    v_cvt_pk_bf16_f32 v16, v24, v25
    v_cvt_pk_bf16_f32 v17, v26, v27
    v_cvt_pk_bf16_f32 v18, v28, v29
    v_cvt_pk_bf16_f32 v19, v30, v31
    buffer_store_dwordx4 v[16:19], v12, s[48:51], s31 offen offset:0 sc1
    v_pk_mul_f32 v[80:81], v[32:33], v[32:33]
    v_pk_mul_f32 v[82:83], v[34:35], v[34:35]
    v_pk_mul_f32 v[84:85], v[36:37], v[36:37]
    v_pk_mul_f32 v[86:87], v[38:39], v[38:39]
    v_pk_fma_f32 v[80:81], v[80:81], s[40:41], v[14:15] op_sel:[0,1,0] op_sel_hi:[1,1,0]
    v_pk_fma_f32 v[82:83], v[82:83], s[40:41], v[14:15] op_sel:[0,1,0] op_sel_hi:[1,1,0]
    v_pk_fma_f32 v[84:85], v[84:85], s[40:41], v[14:15] op_sel:[0,1,0] op_sel_hi:[1,1,0]
    v_pk_fma_f32 v[86:87], v[86:87], s[40:41], v[14:15] op_sel:[0,1,0] op_sel_hi:[1,1,0]
    v_pk_mul_f32 v[80:81], v[80:81], v[32:33]
    v_pk_mul_f32 v[82:83], v[82:83], v[34:35]
    v_pk_mul_f32 v[84:85], v[84:85], v[36:37]
    v_pk_mul_f32 v[86:87], v[86:87], v[38:39]
    v_exp_f32 v80, v80
    v_exp_f32 v81, v81
    v_exp_f32 v82, v82
    v_exp_f32 v83, v83
    v_exp_f32 v84, v84
    v_exp_f32 v85, v85
    v_exp_f32 v86, v86
    v_exp_f32 v87, v87
    v_pk_add_f32 v[80:81], v[80:81], 1.0 op_sel_hi:[1,0]
    v_pk_add_f32 v[82:83], v[82:83], 1.0 op_sel_hi:[1,0]
    v_pk_add_f32 v[84:85], v[84:85], 1.0 op_sel_hi:[1,0]
    v_pk_add_f32 v[86:87], v[86:87], 1.0 op_sel_hi:[1,0]
    v_rcp_f32 v80, v80
    v_rcp_f32 v81, v81
    v_rcp_f32 v82, v82
    v_rcp_f32 v83, v83
    v_rcp_f32 v84, v84
    v_rcp_f32 v85, v85
    v_rcp_f32 v86, v86
    v_rcp_f32 v87, v87
    v_pk_mul_f32 v[40:41], v[40:41], v[32:33]
    v_pk_mul_f32 v[42:43], v[42:43], v[34:35]
    v_pk_mul_f32 v[44:45], v[44:45], v[36:37]
    v_pk_mul_f32 v[46:47], v[46:47], v[38:39]
    v_pk_mul_f32 v[40:41], v[40:41], v[80:81]
    v_pk_mul_f32 v[42:43], v[42:43], v[82:83]
    v_pk_mul_f32 v[44:45], v[44:45], v[84:85]
    v_pk_mul_f32 v[46:47], v[46:47], v[86:87]
    v_cvt_pk_bf16_f32 v32, v40, v41
    v_cvt_pk_bf16_f32 v33, v42, v43
    v_cvt_pk_bf16_f32 v34, v44, v45
    v_cvt_pk_bf16_f32 v35, v46, v47
    buffer_store_dwordx4 v[32:35], v12, s[48:51], s31 offen offset:1024 sc1
    v_pk_mul_f32 v[80:81], v[48:49], v[48:49]
    v_pk_mul_f32 v[82:83], v[50:51], v[50:51]
    v_pk_mul_f32 v[84:85], v[52:53], v[52:53]
    v_pk_mul_f32 v[86:87], v[54:55], v[54:55]
    v_pk_fma_f32 v[80:81], v[80:81], s[40:41], v[14:15] op_sel:[0,1,0] op_sel_hi:[1,1,0]
    v_pk_fma_f32 v[82:83], v[82:83], s[40:41], v[14:15] op_sel:[0,1,0] op_sel_hi:[1,1,0]
    v_pk_fma_f32 v[84:85], v[84:85], s[40:41], v[14:15] op_sel:[0,1,0] op_sel_hi:[1,1,0]
    v_pk_fma_f32 v[86:87], v[86:87], s[40:41], v[14:15] op_sel:[0,1,0] op_sel_hi:[1,1,0]
    v_pk_mul_f32 v[80:81], v[80:81], v[48:49]
    v_pk_mul_f32 v[82:83], v[82:83], v[50:51]
    v_pk_mul_f32 v[84:85], v[84:85], v[52:53]
    v_pk_mul_f32 v[86:87], v[86:87], v[54:55]
    v_exp_f32 v80, v80
    v_exp_f32 v81, v81
    v_exp_f32 v82, v82
    v_exp_f32 v83, v83
    v_exp_f32 v84, v84
    v_exp_f32 v85, v85
    v_exp_f32 v86, v86
    v_exp_f32 v87, v87
    v_pk_add_f32 v[80:81], v[80:81], 1.0 op_sel_hi:[1,0]
    v_pk_add_f32 v[82:83], v[82:83], 1.0 op_sel_hi:[1,0]
    v_pk_add_f32 v[84:85], v[84:85], 1.0 op_sel_hi:[1,0]
    v_pk_add_f32 v[86:87], v[86:87], 1.0 op_sel_hi:[1,0]
    v_rcp_f32 v80, v80
    v_rcp_f32 v81, v81
    v_rcp_f32 v82, v82
    v_rcp_f32 v83, v83
    v_rcp_f32 v84, v84
    v_rcp_f32 v85, v85
    v_rcp_f32 v86, v86
    v_rcp_f32 v87, v87
    v_pk_mul_f32 v[56:57], v[56:57], v[48:49]
    v_pk_mul_f32 v[58:59], v[58:59], v[50:51]
    v_pk_mul_f32 v[60:61], v[60:61], v[52:53]
    v_pk_mul_f32 v[62:63], v[62:63], v[54:55]
    v_pk_mul_f32 v[56:57], v[56:57], v[80:81]
    v_pk_mul_f32 v[58:59], v[58:59], v[82:83]
    v_pk_mul_f32 v[60:61], v[60:61], v[84:85]
    v_pk_mul_f32 v[62:63], v[62:63], v[86:87]
    v_cvt_pk_bf16_f32 v48, v56, v57
    v_cvt_pk_bf16_f32 v49, v58, v59
    v_cvt_pk_bf16_f32 v50, v60, v61
    v_cvt_pk_bf16_f32 v51, v62, v63
    buffer_store_dwordx4 v[48:51], v12, s[48:51], s31 offen offset:2048 sc1
    v_pk_mul_f32 v[80:81], v[64:65], v[64:65]
    v_pk_mul_f32 v[82:83], v[66:67], v[66:67]
    v_pk_mul_f32 v[84:85], v[68:69], v[68:69]
    v_pk_mul_f32 v[86:87], v[70:71], v[70:71]
    v_pk_fma_f32 v[80:81], v[80:81], s[40:41], v[14:15] op_sel:[0,1,0] op_sel_hi:[1,1,0]
    v_pk_fma_f32 v[82:83], v[82:83], s[40:41], v[14:15] op_sel:[0,1,0] op_sel_hi:[1,1,0]
    v_pk_fma_f32 v[84:85], v[84:85], s[40:41], v[14:15] op_sel:[0,1,0] op_sel_hi:[1,1,0]
    v_pk_fma_f32 v[86:87], v[86:87], s[40:41], v[14:15] op_sel:[0,1,0] op_sel_hi:[1,1,0]
    v_pk_mul_f32 v[80:81], v[80:81], v[64:65]
    v_pk_mul_f32 v[82:83], v[82:83], v[66:67]
    v_pk_mul_f32 v[84:85], v[84:85], v[68:69]
    v_pk_mul_f32 v[86:87], v[86:87], v[70:71]
    v_exp_f32 v80, v80
    v_exp_f32 v81, v81
    v_exp_f32 v82, v82
    v_exp_f32 v83, v83
    v_exp_f32 v84, v84
    v_exp_f32 v85, v85
    v_exp_f32 v86, v86
    v_exp_f32 v87, v87
    v_pk_add_f32 v[80:81], v[80:81], 1.0 op_sel_hi:[1,0]
    v_pk_add_f32 v[82:83], v[82:83], 1.0 op_sel_hi:[1,0]
    v_pk_add_f32 v[84:85], v[84:85], 1.0 op_sel_hi:[1,0]
    v_pk_add_f32 v[86:87], v[86:87], 1.0 op_sel_hi:[1,0]
    v_rcp_f32 v80, v80
    v_rcp_f32 v81, v81
    v_rcp_f32 v82, v82
    v_rcp_f32 v83, v83
    v_rcp_f32 v84, v84
    v_rcp_f32 v85, v85
    v_rcp_f32 v86, v86
    v_rcp_f32 v87, v87
    v_pk_mul_f32 v[72:73], v[72:73], v[64:65]
    v_pk_mul_f32 v[74:75], v[74:75], v[66:67]
    v_pk_mul_f32 v[76:77], v[76:77], v[68:69]
    v_pk_mul_f32 v[78:79], v[78:79], v[70:71]
    v_pk_mul_f32 v[72:73], v[72:73], v[80:81]
    v_pk_mul_f32 v[74:75], v[74:75], v[82:83]
    v_pk_mul_f32 v[76:77], v[76:77], v[84:85]
    v_pk_mul_f32 v[78:79], v[78:79], v[86:87]
    v_cvt_pk_bf16_f32 v64, v72, v73
    v_cvt_pk_bf16_f32 v65, v74, v75
    v_cvt_pk_bf16_f32 v66, v76, v77
    v_cvt_pk_bf16_f32 v67, v78, v79
    buffer_store_dwordx4 v[64:67], v12, s[48:51], s31 offen offset:3072 sc1
KB_E:
    s_lshl_b32 s28, s36, 2
    s_add_u32 s28, s28, 139264
    v_mov_b32 v85, s28
    ds_write_b32 v85, v85
    v_lshlrev_b32_e64 v1, 2, v4
    v_add_u32 v1, 139264, v1
    v_and_b32_e64 v13, 3, v2
    v_bfe_u32 v15, v2, 2, 1
    v_mul_u32_u24 v15, 14, v15
    v_add_u32 v13, v13, v15
    v_lshlrev_b32 v13, 7, v13
    s_lshl_b32 s28, s20, 2
    s_add_u32 s28, s28, 139360
    v_mov_b32 v86, s28
    v_lshlrev_b32 v11, 9, v7
    v_lshl_add_u32 v11, v6, 4, v11
    v_xor_b32 v10, v7, v6
    v_and_b32 v10, 1, v10
    v_lshrrev_b32 v15, 1, v7
    v_xor_b32 v15, v15, v4
    v_lshl_add_u32 v10, v10, 3, v15
    v_lshlrev_b32_e64 v10, 4, v10
    v_lshl_add_u32 v10, v6, 8, v10
    s_lshl_b32 s29, s36, 13
    v_add_u32 v10, s29, v10
    v_lshlrev_b32 v84, 4, v2
    v_mov_b32 v80, s100
    v_mov_b32 v81, s100
    v_mov_b32 v82, s100
    v_mov_b32_e64 v83, s100
    s_add_u32 s16, s6, 4194304
    s_addc_u32 s17, s7, 0
    s_mov_b32 s18, 1835008
    s_mov_b32 s19, 0x00020000
    s_add_u32 s44, s6, 1835008
    s_addc_u32 s45, s7, 0
    s_mov_b32 s46, 12288
    s_mov_b32 s47, 0x00020000
    s_and_b32 s52, s36, 4
    s_add_u32 s52, s52, s39
    s_lshr_b32 s53, s52, 1
    s_lshl_b32 s55, s21, 1
    s_lshr_b32 s56, s53, 1
    s_add_u32 s55, s55, s56
    s_sub_u32 s56, 32, s55
    s_cmp_eq_u32 s55, 0
    s_cselect_b32 s56, 16, s56
    s_bitcmp1_b32 s53, 0
    s_cselect_b32 s54, s56, s55
    s_and_b32 s55, s52, 1
    s_lshl_b32 s55, s55, 2
    s_add_u32 s55, s55, s20
    s_sub_u32 s40, 64, s54
    s_cmp_eq_u32 s54, 0
    s_cselect_b32 s40, 32, s40
    v_mov_b32 v9, s40
    v_mov_b32 v8, s54
    v_cmp_gt_u32 vcc, 4, v3
    s_nop 1
    v_cndmask_b32 v9, v9, v8, vcc
    v_and_b32 v8, 3, v3
    s_lshl_b32 s41, s55, 2
    v_add_u32_e64 v8, s41, v8
    v_lshl_add_u32 v9, v8, 6, v9
    v_mul_u32_u24 v9, 896, v9
    v_lshl_add_u32 v9, v4, 4, v9
    s_lshl_b32 s57, s42, 7
    s_lshl_b32 s58, s21, 3
    s_add_u32 s58, s58, s52
    s_mul_i32 s58, s58, 28672
    s_lshl_b32 s59, s42, 12
    s_add_u32 s58, s58, s59
    s_lshl_b32 s59, s20, 7
    s_add_u32 s58, s58, s59
    v_lshlrev_b32 v8, 9, v4
    v_lshl_add_u32 v8, v3, 4, v8
    v_lshlrev_b32 v14, 5, v4
    s_lshl_b32 s59, s42, 8
    s_add_u32 s59, s59, 10240
    s_mov_b32 s53, s60
    s_lshl_b32 s60, s20, 3
    v_add_u32 v12, s60, v3
    v_lshlrev_b32 v12, 8, v12
    v_xor_b32_e64 v15, v3, v4
    v_lshl_add_u32 v12, v15, 4, v12
    v_and_b32_e64 v15, 1, v3
    v_lshl_add_u32 v12, v15, 7, v12
    s_lshr_b32 s60, s36, 2
    s_lshl_b32 s60, s60, 16
    v_add_u32 v12, s60, v12
    s_waitcnt vmcnt(0)
    s_mov_b64 exec, 0xff
    buffer_store_dwordx4 v[80:83], v84, s[12:15], s27 offen sc1
    s_mov_b64 exec, -1
    s_setprio 3
    v_mov_b32_e64 v84, 1
    s_cmp_ge_u32 s36, 4
    s_cbranch_scc1 KB_t0
    s_mul_i32 s61, s20, 6144
    s_add_u32 s61, s61, 114688
    s_lshl_b32 s30, s20, 12
    s_add_u32 s30, s30, 147456
    s_mov_b32 s60, s53
    s_mov_b32 s52, s34
    s_mov_b32 s53, s35
    s_mov_b32 s54, 1605632
    s_mov_b32 s55, 0x00020000
    s_mov_b32 s33, 0
KW_r:
    ds_read_b32 v15, v86 offset:32
    s_add_u32 s33, s33, 1
    s_waitcnt lgkmcnt(0)
    v_cmp_eq_u32_e64 vcc, 0, v15
    s_nop 0
    s_cbranch_vccz KWD_r
    s_sleep 2
    s_cmp_lt_u32 s33, 800000
    s_cbranch_scc1 KW_r
KWD_r:
    v_lshrrev_b32 v132, 2, v6
    v_lshl_add_u32 v132, v7, 2, v132
    v_bfe_u32 v133, v132, 1, 2
    v_lshlrev_b32 v132, 7, v132
    v_and_b32 v134, 3, v6
    v_lshl_add_u32 v132, v134, 3, v132
    v_xor_b32_e64 v134, 0, v133
    v_lshl_add_u32 v134, v134, 5, v132
    v_add_u32 v136, s61, v134
    v_add_u32 v140, s30, v134
    v_xor_b32_e64 v134, 1, v133
    v_lshl_add_u32 v134, v134, 5, v132
    v_add_u32 v137, s61, v134
    v_add_u32 v141, s30, v134
    v_xor_b32_e64 v134, 2, v133
    v_lshl_add_u32 v134, v134, 5, v132
    v_add_u32 v138, s61, v134
    v_add_u32 v142, s30, v134
    v_xor_b32_e64 v134, 3, v133
    v_lshl_add_u32 v134, v134, 5, v132
    v_add_u32 v139, s61, v134
    v_add_u32 v143, s30, v134
    s_add_u32 s60, s60, 71680
    ds_read_b64_tr_b16 a[34:35], v136 offset:0
    ds_read_b64_tr_b16 a[38:39], v137 offset:0
    ds_read_b64_tr_b16 a[42:43], v138 offset:0
    ds_read_b64_tr_b16 a[46:47], v139 offset:0
    s_waitcnt lgkmcnt(0)
    s_add_u32 m0, s61, 0
    s_add_u32 s28, s60, 7168
    buffer_load_dwordx4 v5, s[52:55], s60 offen lds
    s_add_u32 m0, s61, 1024
    s_add_u32 s60, s60, 14336
    buffer_load_dwordx4 v5, s[52:55], s28 offen lds
    ds_read_b64_tr_b16 a[48:49], v136 offset:2048
    ds_read_b64_tr_b16 a[52:53], v137 offset:2048
    ds_read_b64_tr_b16 a[56:57], v138 offset:2048
    ds_read_b64_tr_b16 a[60:61], v139 offset:2048
    s_waitcnt lgkmcnt(0)
    s_add_u32 m0, s61, 2048
    s_add_u32 s28, s60, 7168
    buffer_load_dwordx4 v5, s[52:55], s60 offen lds
    s_add_u32 m0, s61, 3072
    s_add_u32 s60, s60, 14336
    buffer_load_dwordx4 v5, s[52:55], s28 offen lds
    ds_read_b64_tr_b16 a[50:51], v136 offset:4096
    ds_read_b64_tr_b16 a[54:55], v137 offset:4096
    ds_read_b64_tr_b16 a[58:59], v138 offset:4096
    ds_read_b64_tr_b16 a[62:63], v139 offset:4096
    s_waitcnt lgkmcnt(0)
    s_add_u32 m0, s61, 4096
    s_add_u32 s28, s60, 7168
    buffer_load_dwordx4 v5, s[52:55], s60 offen lds
    s_add_u32 m0, s61, 5120
    s_add_u32 s60, s60, 14336
    buffer_load_dwordx4 v5, s[52:55], s28 offen lds
    ds_read_b64_tr_b16 a[64:65], v140 offset:0
    ds_read_b64_tr_b16 a[68:69], v141 offset:0
    ds_read_b64_tr_b16 a[72:73], v142 offset:0
    ds_read_b64_tr_b16 a[76:77], v143 offset:0
    s_waitcnt lgkmcnt(0)
    s_add_u32 m0, s30, 0
    s_add_u32 s28, s60, 7168
    buffer_load_dwordx4 v5, s[52:55], s60 offen lds
    s_add_u32 m0, s30, 1024
    s_add_u32 s60, s60, 14336
    buffer_load_dwordx4 v5, s[52:55], s28 offen lds
    ds_read_b64_tr_b16 a[66:67], v140 offset:2048
    ds_read_b64_tr_b16 a[70:71], v141 offset:2048
    ds_read_b64_tr_b16 a[74:75], v142 offset:2048
    ds_read_b64_tr_b16 a[78:79], v143 offset:2048
    s_lshl_b32 s28, s21, 3
    s_add_u32 s28, s28, s39
    s_lshl_b32 s28, s28, 2
    s_add_u32 s28, s28, s20
    s_lshl_b32 s28, s28, 9
    s_add_u32 s28, s28, 425984
    s_sub_u32 s28, s28, s26
    v_and_b32 v87, 3, v2
    v_lshlrev_b32 v87, 7, v87
    v_bfe_u32 v15, v2, 2, 1
    v_lshl_add_u32 v87, v15, 13, v87
    v_add_u32 v87, s28, v87
    v_cmp_gt_u32 vcc, 8, v2
    s_nop 1
    v_cndmask_b32_e64 v87, v87, v13, vcc
    s_mov_b32 s33, 0
PL_e:
    buffer_load_dword v15, v87, s[12:15], s26 offen sc1
    s_add_u32 s33, s33, 1
    s_waitcnt vmcnt(0)
PC_e:
    v_cmp_ne_u32 vcc, s100, v15
    s_nop 0
    s_cbranch_vccz PD_e
    s_mov_b64 exec, vcc
    s_cmp_lt_u32 s33, 200000
    s_cbranch_scc1 PL_e
PD_e:
    s_mov_b64 exec, -1
    ds_read_b64_tr_b16 a[80:81], v136 offset:0
    ds_read_b64_tr_b16 a[84:85], v137 offset:0
    ds_read_b64_tr_b16 a[88:89], v138 offset:0
    ds_read_b64_tr_b16 a[92:93], v139 offset:0
    ds_read_b64_tr_b16 a[82:83], v136 offset:2048
    ds_read_b64_tr_b16 a[86:87], v137 offset:2048
    ds_read_b64_tr_b16 a[90:91], v138 offset:2048
    ds_read_b64_tr_b16 a[94:95], v139 offset:2048
    ds_read_b64_tr_b16 a[96:97], v136 offset:4096
    ds_read_b64_tr_b16 a[100:101], v137 offset:4096
    ds_read_b64_tr_b16 a[104:105], v138 offset:4096
    ds_read_b64_tr_b16 a[108:109], v139 offset:4096
    ds_read_b64_tr_b16 a[98:99], v140 offset:0
    ds_read_b64_tr_b16 a[102:103], v141 offset:0
    ds_read_b64_tr_b16 a[106:107], v142 offset:0
    ds_read_b64_tr_b16 a[110:111], v143 offset:0
    ds_write_b32 v86, v84
    s_add_u32 s28, s32, 0
    buffer_load_dwordx4 v[88:91], v11, s[48:51], s28 offen offset:0 sc1
    buffer_load_dwordx4 v[92:95], v11, s[48:51], s28 offen offset:256 sc1
    buffer_load_dwordx4 v[96:99], v11, s[48:51], s28 offen offset:2048 sc1
    buffer_load_dwordx4 v[100:103], v11, s[48:51], s28 offen offset:2304 sc1
    s_add_u32 s28, s32, 4096
    buffer_load_dwordx4 v[104:107], v11, s[48:51], s28 offen offset:0 sc1
    buffer_load_dwordx4 v[108:111], v11, s[48:51], s28 offen offset:256 sc1
    s_waitcnt vmcnt(5)
    buffer_load_dwordx4 v[112:115], v11, s[48:51], s28 offen offset:2048 sc1
    s_waitcnt vmcnt(5)
    buffer_load_dwordx4 v[116:119], v11, s[48:51], s28 offen offset:2304 sc1
    s_waitcnt vmcnt(5)
    s_add_u32 s28, s32, 8192
    buffer_load_dwordx4 v[120:123], v11, s[48:51], s28 offen offset:0 sc1
    s_waitcnt vmcnt(5)
    buffer_load_dwordx4 v[124:127], v11, s[48:51], s28 offen offset:256 sc1
    s_waitcnt vmcnt(5)
    buffer_load_dwordx4 v[128:131], v11, s[48:51], s28 offen offset:2048 sc1
    s_waitcnt vmcnt(5)
    buffer_load_dwordx4 v[132:135], v11, s[48:51], s28 offen offset:2304 sc1
    s_waitcnt vmcnt(5)
    s_add_u32 s28, s32, 12288
    buffer_load_dwordx4 v[136:139], v11, s[48:51], s28 offen offset:0 sc1
    s_waitcnt vmcnt(5)
    buffer_load_dwordx4 v[140:143], v11, s[48:51], s28 offen offset:256 sc1
    s_branch KB_t0b
KB_t0:
    s_mov_b32 s33, 0
KW_eb:
    ds_read_b32 v15, v86 offset:0
    s_add_u32 s33, s33, 1
    s_waitcnt lgkmcnt(0)
    v_cmp_eq_u32_e64 vcc, 0, v15
    s_nop 0
    s_cbranch_vccz KWD_eb
    s_sleep 2
    s_cmp_lt_u32 s33, 800000
    s_cbranch_scc1 KW_eb
KWD_eb:
    s_add_u32 s28, s32, 0
    buffer_load_dwordx4 v[88:91], v11, s[48:51], s28 offen offset:0 sc1
    buffer_load_dwordx4 v[92:95], v11, s[48:51], s28 offen offset:256 sc1
    buffer_load_dwordx4 v[96:99], v11, s[48:51], s28 offen offset:2048 sc1
    buffer_load_dwordx4 v[100:103], v11, s[48:51], s28 offen offset:2304 sc1
    s_add_u32 s28, s32, 4096
    buffer_load_dwordx4 v[104:107], v11, s[48:51], s28 offen offset:0 sc1
    buffer_load_dwordx4 v[108:111], v11, s[48:51], s28 offen offset:256 sc1
    buffer_load_dwordx4 v[112:115], v11, s[48:51], s28 offen offset:2048 sc1
    buffer_load_dwordx4 v[116:119], v11, s[48:51], s28 offen offset:2304 sc1
    s_add_u32 s28, s32, 8192
    buffer_load_dwordx4 v[120:123], v11, s[48:51], s28 offen offset:0 sc1
    buffer_load_dwordx4 v[124:127], v11, s[48:51], s28 offen offset:256 sc1
    buffer_load_dwordx4 v[128:131], v11, s[48:51], s28 offen offset:2048 sc1
    buffer_load_dwordx4 v[132:135], v11, s[48:51], s28 offen offset:2304 sc1
    s_add_u32 s28, s32, 12288
    buffer_load_dwordx4 v[136:139], v11, s[48:51], s28 offen offset:0 sc1
    buffer_load_dwordx4 v[140:143], v11, s[48:51], s28 offen offset:256 sc1
KB_t0b:
    s_add_u32 s26, s26, 16384
    s_add_u32 s32, s32, 458752
    s_lshl_b32 s30, s42, 11
    s_add_u32 s30, s30, s32
    v_bfe_u32 v81, v2, 4, 1
    v_mul_u32_u24 v81, 57344, v81
    v_lshl_add_u32 v82, v6, 7, v81
    s_setprio 0
    s_mov_b32 s33, 0
KW_a:
    ds_read_b32 v15, v1 offset:0
    s_add_u32 s33, s33, 1
    s_waitcnt lgkmcnt(0)
    v_cmp_eq_u32 vcc, 0, v15
    s_nop 0
    s_cbranch_vccz KWD_a
    s_sleep 2
    s_cmp_lt_u32 s33, 800000
    s_cbranch_scc1 KW_a
KWD_a:
    s_waitcnt vmcnt(13)
    v_mfma_f32_16x16x32_bf16 v[24:27], a[0:3], v[88:91], 0
    v_mfma_f32_16x16x32_bf16 v[28:31], a[4:7], v[88:91], 0
    v_mfma_f32_16x16x32_bf16 v[40:43], a[8:11], v[88:91], 0
    v_mfma_f32_16x16x32_bf16 v[44:47], a[12:15], v[88:91], 0
    s_waitcnt vmcnt(12)
    v_mfma_f32_16x16x32_bf16 v[56:59], a[0:3], v[92:95], 0
    v_mfma_f32_16x16x32_bf16 v[60:63], a[4:7], v[92:95], 0
    v_mfma_f32_16x16x32_bf16 v[72:75], a[8:11], v[92:95], 0
    v_mfma_f32_16x16x32_bf16 v[76:79], a[12:15], v[92:95], 0
    s_waitcnt vmcnt(11)
    v_mfma_f32_16x16x32_bf16 v[24:27], a[16:19], v[96:99], v[24:27]
    v_mfma_f32_16x16x32_bf16 v[28:31], a[20:23], v[96:99], v[28:31]
    v_mfma_f32_16x16x32_bf16 v[40:43], a[24:27], v[96:99], v[40:43]
    v_mfma_f32_16x16x32_bf16 v[44:47], a[28:31], v[96:99], v[44:47]
    s_waitcnt vmcnt(10)
    v_mfma_f32_16x16x32_bf16 v[56:59], a[16:19], v[100:103], v[56:59]
    v_mfma_f32_16x16x32_bf16 v[60:63], a[20:23], v[100:103], v[60:63]
    v_mfma_f32_16x16x32_bf16 v[72:75], a[24:27], v[100:103], v[72:75]
    v_mfma_f32_16x16x32_bf16 v[76:79], a[28:31], v[100:103], v[76:79]
    s_waitcnt vmcnt(9)
    v_mfma_f32_16x16x32_bf16 v[24:27], a[32:35], v[104:107], v[24:27]
    v_mfma_f32_16x16x32_bf16 v[28:31], a[36:39], v[104:107], v[28:31]
    v_mfma_f32_16x16x32_bf16 v[40:43], a[40:43], v[104:107], v[40:43]
    v_mfma_f32_16x16x32_bf16 v[44:47], a[44:47], v[104:107], v[44:47]
    s_waitcnt vmcnt(8)
    v_mfma_f32_16x16x32_bf16 v[56:59], a[32:35], v[108:111], v[56:59]
    v_mfma_f32_16x16x32_bf16 v[60:63], a[36:39], v[108:111], v[60:63]
    v_mfma_f32_16x16x32_bf16 v[72:75], a[40:43], v[108:111], v[72:75]
    v_mfma_f32_16x16x32_bf16 v[76:79], a[44:47], v[108:111], v[76:79]
    s_waitcnt vmcnt(7)
    v_mfma_f32_16x16x32_bf16 v[24:27], a[48:51], v[112:115], v[24:27]
    v_mfma_f32_16x16x32_bf16 v[28:31], a[52:55], v[112:115], v[28:31]
    v_mfma_f32_16x16x32_bf16 v[40:43], a[56:59], v[112:115], v[40:43]
    v_mfma_f32_16x16x32_bf16 v[44:47], a[60:63], v[112:115], v[44:47]
    s_waitcnt vmcnt(6)
    v_mfma_f32_16x16x32_bf16 v[56:59], a[48:51], v[116:119], v[56:59]
    v_mfma_f32_16x16x32_bf16 v[60:63], a[52:55], v[116:119], v[60:63]
    v_mfma_f32_16x16x32_bf16 v[72:75], a[56:59], v[116:119], v[72:75]
    v_mfma_f32_16x16x32_bf16 v[76:79], a[60:63], v[116:119], v[76:79]
    s_waitcnt vmcnt(5)
    v_mfma_f32_16x16x32_bf16 v[24:27], a[64:67], v[120:123], v[24:27]
    v_mfma_f32_16x16x32_bf16 v[28:31], a[68:71], v[120:123], v[28:31]
    v_mfma_f32_16x16x32_bf16 v[40:43], a[72:75], v[120:123], v[40:43]
    v_mfma_f32_16x16x32_bf16 v[44:47], a[76:79], v[120:123], v[44:47]
    s_waitcnt vmcnt(4)
    v_mfma_f32_16x16x32_bf16 v[56:59], a[64:67], v[124:127], v[56:59]
    v_mfma_f32_16x16x32_bf16 v[60:63], a[68:71], v[124:127], v[60:63]
    v_mfma_f32_16x16x32_bf16 v[72:75], a[72:75], v[124:127], v[72:75]
    v_mfma_f32_16x16x32_bf16 v[76:79], a[76:79], v[124:127], v[76:79]
    s_waitcnt vmcnt(3)
    v_mfma_f32_16x16x32_bf16 v[24:27], a[80:83], v[128:131], v[24:27]
    v_mfma_f32_16x16x32_bf16 v[28:31], a[84:87], v[128:131], v[28:31]
    v_mfma_f32_16x16x32_bf16 v[40:43], a[88:91], v[128:131], v[40:43]
    v_mfma_f32_16x16x32_bf16 v[44:47], a[92:95], v[128:131], v[44:47]
    s_waitcnt vmcnt(2)
    v_mfma_f32_16x16x32_bf16 v[56:59], a[80:83], v[132:135], v[56:59]
    v_mfma_f32_16x16x32_bf16 v[60:63], a[84:87], v[132:135], v[60:63]
    v_mfma_f32_16x16x32_bf16 v[72:75], a[88:91], v[132:135], v[72:75]
    v_mfma_f32_16x16x32_bf16 v[76:79], a[92:95], v[132:135], v[76:79]
    s_waitcnt vmcnt(1)
    v_mfma_f32_16x16x32_bf16 v[24:27], a[96:99], v[136:139], v[24:27]
    v_mfma_f32_16x16x32_bf16 v[28:31], a[100:103], v[136:139], v[28:31]
    v_mfma_f32_16x16x32_bf16 v[40:43], a[104:107], v[136:139], v[40:43]
    v_mfma_f32_16x16x32_bf16 v[44:47], a[108:111], v[136:139], v[44:47]
    s_waitcnt vmcnt(0)
    v_mfma_f32_16x16x32_bf16 v[56:59], a[96:99], v[140:143], v[56:59]
    v_mfma_f32_16x16x32_bf16 v[60:63], a[100:103], v[140:143], v[60:63]
    v_mfma_f32_16x16x32_bf16 v[72:75], a[104:107], v[140:143], v[72:75]
    v_mfma_f32_16x16x32_bf16 v[76:79], a[108:111], v[140:143], v[76:79]
    s_cmp_ge_u32 s36, 4
    s_cbranch_scc1 KB_t2
    buffer_load_dword v87, v13, s[12:15], s26 offen sc1
KB_t2:
    s_nop 4
    v_xor_b32 v0, 32, v10
    v_xor_b32 v3, 64, v10
    v_xor_b32 v7, 96, v10
    ds_write_b128 v10, v[24:27] offset:0
    ds_write_b128 v0, v[28:31] offset:0
    ds_write_b128 v3, v[40:43] offset:0
    ds_write_b128 v7, v[44:47] offset:0
    ds_write_b128 v10, v[56:59] offset:4096
    ds_write_b128 v0, v[60:63] offset:4096
    ds_write_b128 v3, v[72:75] offset:4096
    ds_write_b128 v7, v[76:79] offset:4096
    ds_write_b32 v85, v84 offset:32
    s_cmp_ge_u32 s36, 4
    s_cbranch_scc1 KB_t3
    s_waitcnt vmcnt(0)
    s_mov_b32 s33, 0
    s_branch PC_l
PL_l:
    buffer_load_dword v87, v13, s[12:15], s26 offen sc1
    s_add_u32 s33, s33, 1
    s_waitcnt vmcnt(0)
PC_l:
    v_cmp_ne_u32_e64 vcc, s100, v87
    s_nop 0
    s_cbranch_vccz PD_l
    s_mov_b64 exec, vcc
    s_cmp_lt_u32 s33, 200000
    s_cbranch_scc1 PL_l
PD_l:
    s_mov_b64 exec, -1
    ds_write_b32 v86, v84 offset:16
    s_branch KB_t4
KB_t3:
    s_mov_b32 s33, 0
KW_lb:
    ds_read_b32 v15, v86 offset:16
    s_add_u32 s33, s33, 1
    s_waitcnt lgkmcnt(0)
    v_cmp_eq_u32_e64 vcc, 0, v15
    s_nop 0
    s_cbranch_vccz KWD_lb
    s_cmp_lt_u32 s33, 800000
    s_cbranch_scc1 KW_lb
KWD_lb:
    s_mov_b64 exec, 15
    s_mov_b32 s33, 0
KW_nb:
    ds_read_b32 v15, v1 offset:96
    s_add_u32 s33, s33, 1
    s_waitcnt lgkmcnt(0)
    v_cmp_eq_u32 vcc, 0, v15
    s_nop 0
    s_cbranch_vccz KWD_nb
    s_cmp_lt_u32 s33, 800000
    s_cbranch_scc1 KW_nb
KWD_nb:
    s_mov_b64 exec, -1
KB_t4:
    s_add_u32 s28, s32, 0
    buffer_load_dwordx4 v[88:91], v11, s[48:51], s28 offen offset:0 sc1
    buffer_load_dwordx4 v[92:95], v11, s[48:51], s28 offen offset:256 sc1
    buffer_load_dwordx4 v[96:99], v11, s[48:51], s28 offen offset:2048 sc1
    buffer_load_dwordx4 v[100:103], v11, s[48:51], s28 offen offset:2304 sc1
    s_add_u32 s28, s32, 4096
    buffer_load_dwordx4 v[104:107], v11, s[48:51], s28 offen offset:0 sc1
    buffer_load_dwordx4 v[108:111], v11, s[48:51], s28 offen offset:256 sc1
    buffer_load_dwordx4 v[112:115], v11, s[48:51], s28 offen offset:2048 sc1
    buffer_load_dwordx4 v[116:119], v11, s[48:51], s28 offen offset:2304 sc1
    s_waitcnt lgkmcnt(0)
    v_add_u32 v10, 65536, v10
    v_xor_b32 v13, 128, v12
    s_mov_b32 s12, s62
    s_mov_b32 s13, s63
    s_mov_b32 s14, 1835008
    s_mov_b32 s15, 0x00020000
    s_and_b32 s28, s36, 4
    s_lshl_b32 s28, s28, 3
    v_add_u32_e64 v1, s28, v1
    s_add_u32 s28, s32, 8192
    s_waitcnt vmcnt(7)
    v_mfma_f32_16x16x32_bf16 v[16:19], a[0:3], v[88:91], 0
    v_mfma_f32_16x16x32_bf16 v[20:23], a[4:7], v[88:91], 0
    v_mfma_f32_16x16x32_bf16 v[32:35], a[8:11], v[88:91], 0
    v_mfma_f32_16x16x32_bf16 v[36:39], a[12:15], v[88:91], 0
    s_add_u32 s28, s32, 8192
    buffer_load_dwordx4 v[120:123], v11, s[48:51], s28 offen offset:0 sc1
    s_waitcnt vmcnt(7)
    v_mfma_f32_16x16x32_bf16 v[48:51], a[0:3], v[92:95], 0
    v_mfma_f32_16x16x32_bf16 v[52:55], a[4:7], v[92:95], 0
    v_mfma_f32_16x16x32_bf16 v[64:67], a[8:11], v[92:95], 0
    v_mfma_f32_16x16x32_bf16 v[68:71], a[12:15], v[92:95], 0
    buffer_load_dwordx4 v[124:127], v11, s[48:51], s28 offen offset:256 sc1
    s_waitcnt vmcnt(7)
    v_mfma_f32_16x16x32_bf16 v[16:19], a[16:19], v[96:99], v[16:19]
    v_mfma_f32_16x16x32_bf16 v[20:23], a[20:23], v[96:99], v[20:23]
    v_mfma_f32_16x16x32_bf16 v[32:35], a[24:27], v[96:99], v[32:35]
    v_mfma_f32_16x16x32_bf16 v[36:39], a[28:31], v[96:99], v[36:39]
    buffer_load_dwordx4 v[128:131], v11, s[48:51], s28 offen offset:2048 sc1
    s_waitcnt vmcnt(7)
    v_mfma_f32_16x16x32_bf16 v[48:51], a[16:19], v[100:103], v[48:51]
    v_mfma_f32_16x16x32_bf16 v[52:55], a[20:23], v[100:103], v[52:55]
    v_mfma_f32_16x16x32_bf16 v[64:67], a[24:27], v[100:103], v[64:67]
    v_mfma_f32_16x16x32_bf16 v[68:71], a[28:31], v[100:103], v[68:71]
    buffer_load_dwordx4 v[132:135], v11, s[48:51], s28 offen offset:2304 sc1
    s_waitcnt vmcnt(7)
    v_mfma_f32_16x16x32_bf16 v[16:19], a[32:35], v[104:107], v[16:19]
    v_mfma_f32_16x16x32_bf16 v[20:23], a[36:39], v[104:107], v[20:23]
    v_mfma_f32_16x16x32_bf16 v[32:35], a[40:43], v[104:107], v[32:35]
    v_mfma_f32_16x16x32_bf16 v[36:39], a[44:47], v[104:107], v[36:39]
    s_add_u32 s28, s32, 12288
    buffer_load_dwordx4 v[136:139], v11, s[48:51], s28 offen offset:0 sc1
    s_waitcnt vmcnt(7)
    v_mfma_f32_16x16x32_bf16 v[48:51], a[32:35], v[108:111], v[48:51]
    v_mfma_f32_16x16x32_bf16 v[52:55], a[36:39], v[108:111], v[52:55]
    v_mfma_f32_16x16x32_bf16 v[64:67], a[40:43], v[108:111], v[64:67]
    v_mfma_f32_16x16x32_bf16 v[68:71], a[44:47], v[108:111], v[68:71]
    buffer_load_dwordx4 v[140:143], v11, s[48:51], s28 offen offset:256 sc1
    s_waitcnt vmcnt(7)
    v_mfma_f32_16x16x32_bf16 v[16:19], a[48:51], v[112:115], v[16:19]
    v_mfma_f32_16x16x32_bf16 v[20:23], a[52:55], v[112:115], v[20:23]
    v_mfma_f32_16x16x32_bf16 v[32:35], a[56:59], v[112:115], v[32:35]
    v_mfma_f32_16x16x32_bf16 v[36:39], a[60:63], v[112:115], v[36:39]
    buffer_load_dwordx4 v[80:83], v8, s[16:19], s58 offen sc1
    s_waitcnt vmcnt(7)
    v_mfma_f32_16x16x32_bf16 v[48:51], a[48:51], v[116:119], v[48:51]
    v_mfma_f32_16x16x32_bf16 v[52:55], a[52:55], v[116:119], v[52:55]
    v_mfma_f32_16x16x32_bf16 v[64:67], a[56:59], v[116:119], v[64:67]
    v_mfma_f32_16x16x32_bf16 v[68:71], a[60:63], v[116:119], v[68:71]
    buffer_load_dwordx4 v[24:27], v14, s[44:47], s59 offen sc1
    s_waitcnt vmcnt(7)
    v_mfma_f32_16x16x32_bf16 v[16:19], a[64:67], v[120:123], v[16:19]
    v_mfma_f32_16x16x32_bf16 v[20:23], a[68:71], v[120:123], v[20:23]
    v_mfma_f32_16x16x32_bf16 v[32:35], a[72:75], v[120:123], v[32:35]
    v_mfma_f32_16x16x32_bf16 v[36:39], a[76:79], v[120:123], v[36:39]
    buffer_load_dwordx4 v[28:31], v14, s[44:47], s59 offen offset:16 sc1
    s_waitcnt vmcnt(7)
    v_mfma_f32_16x16x32_bf16 v[48:51], a[64:67], v[124:127], v[48:51]
    v_mfma_f32_16x16x32_bf16 v[52:55], a[68:71], v[124:127], v[52:55]
    v_mfma_f32_16x16x32_bf16 v[64:67], a[72:75], v[124:127], v[64:67]
    v_mfma_f32_16x16x32_bf16 v[68:71], a[76:79], v[124:127], v[68:71]
    s_waitcnt vmcnt(6)
    v_mfma_f32_16x16x32_bf16 v[16:19], a[80:83], v[128:131], v[16:19]
    v_mfma_f32_16x16x32_bf16 v[20:23], a[84:87], v[128:131], v[20:23]
    v_mfma_f32_16x16x32_bf16 v[32:35], a[88:91], v[128:131], v[32:35]
    v_mfma_f32_16x16x32_bf16 v[36:39], a[92:95], v[128:131], v[36:39]
    s_waitcnt vmcnt(5)
    v_mfma_f32_16x16x32_bf16 v[48:51], a[80:83], v[132:135], v[48:51]
    v_mfma_f32_16x16x32_bf16 v[52:55], a[84:87], v[132:135], v[52:55]
    v_mfma_f32_16x16x32_bf16 v[64:67], a[88:91], v[132:135], v[64:67]
    v_mfma_f32_16x16x32_bf16 v[68:71], a[92:95], v[132:135], v[68:71]
    s_waitcnt vmcnt(4)
    v_mfma_f32_16x16x32_bf16 v[16:19], a[96:99], v[136:139], v[16:19]
    v_mfma_f32_16x16x32_bf16 v[20:23], a[100:103], v[136:139], v[20:23]
    v_mfma_f32_16x16x32_bf16 v[32:35], a[104:107], v[136:139], v[32:35]
    v_mfma_f32_16x16x32_bf16 v[36:39], a[108:111], v[136:139], v[36:39]
    s_waitcnt vmcnt(3)
    v_mfma_f32_16x16x32_bf16 v[48:51], a[96:99], v[140:143], v[48:51]
    v_mfma_f32_16x16x32_bf16 v[52:55], a[100:103], v[140:143], v[52:55]
    v_mfma_f32_16x16x32_bf16 v[64:67], a[104:107], v[140:143], v[64:67]
    v_mfma_f32_16x16x32_bf16 v[68:71], a[108:111], v[140:143], v[68:71]
    v_xor_b32 v0, 32, v10
    v_xor_b32 v3, 64, v10
    v_xor_b32 v7, 96, v10
    ds_write_b128 v10, v[16:19] offset:0
    ds_write_b128 v0, v[20:23] offset:0
    ds_write_b128 v3, v[32:35] offset:0
    ds_write_b128 v7, v[36:39] offset:0
    ds_write_b128 v10, v[48:51] offset:4096
    ds_write_b128 v0, v[52:55] offset:4096
    ds_write_b128 v3, v[64:67] offset:4096
    ds_write_b128 v7, v[68:71] offset:4096
    ds_write_b32 v85, v84 offset:64
    s_waitcnt vmcnt(2)
    v_lshlrev_b32 v40, 16, v80
    v_and_b32 v41, 0xffff0000, v80
    v_lshlrev_b32_e64 v42, 16, v81
    v_and_b32 v43, 0xffff0000, v81
    v_lshlrev_b32_e64 v44, 16, v82
    v_and_b32 v45, 0xffff0000, v82
    v_lshlrev_b32_e64 v46, 16, v83
    v_and_b32 v47, 0xffff0000, v83
    s_mov_b64 exec, 15
    s_mov_b32 s33, 0
KW_c0:
    ds_read_b32 v15, v1 offset:32
    s_add_u32 s33, s33, 1
    s_waitcnt lgkmcnt(0)
    v_cmp_eq_u32_e64 vcc, 0, v15
    s_nop 0
    s_cbranch_vccz KWD_c0
    s_cmp_lt_u32 s33, 800000
    s_cbranch_scc1 KW_c0
KWD_c0:
    s_mov_b64 exec, -1
    ds_read_b128 v[88:91], v12 offset:0
    ds_read_b128 v[92:95], v13 offset:0
    ds_read_b128 v[96:99], v12 offset:8192
    ds_read_b128 v[100:103], v13 offset:8192
    ds_read_b128 v[104:107], v12 offset:16384
    ds_read_b128 v[108:111], v13 offset:16384
    ds_read_b128 v[112:115], v12 offset:24576
    ds_read_b128 v[116:119], v13 offset:24576
    s_waitcnt lgkmcnt(4)
    v_pk_add_f32 v[88:89], v[88:89], v[96:97]
    v_pk_add_f32 v[90:91], v[90:91], v[98:99]
    v_pk_add_f32 v[92:93], v[92:93], v[100:101]
    v_pk_add_f32 v[94:95], v[94:95], v[102:103]
    s_waitcnt lgkmcnt(2)
    v_pk_add_f32 v[88:89], v[88:89], v[104:105]
    v_pk_add_f32 v[90:91], v[90:91], v[106:107]
    v_pk_add_f32 v[92:93], v[92:93], v[108:109]
    v_pk_add_f32 v[94:95], v[94:95], v[110:111]
    s_waitcnt lgkmcnt(0)
    v_pk_add_f32 v[88:89], v[88:89], v[112:113]
    v_pk_add_f32 v[90:91], v[90:91], v[114:115]
    v_pk_add_f32 v[92:93], v[92:93], v[116:117]
    v_pk_add_f32 v[94:95], v[94:95], v[118:119]
    s_mov_b64 exec, 240
    s_mov_b32 s33, 0
KW_c1:
    ds_read_b32 v15, v1 offset:32
    s_add_u32 s33, s33, 1
    s_waitcnt lgkmcnt(0)
    v_cmp_eq_u32_e64 vcc, 0, v15
    s_nop 0
    s_cbranch_vccz KWD_c1
    s_cmp_lt_u32 s33, 800000
    s_cbranch_scc1 KW_c1
KWD_c1:
    s_mov_b64 exec, -1
    ds_read_b128 v[96:99], v12 offset:32768
    ds_read_b128 v[100:103], v13 offset:32768
    ds_read_b128 v[104:107], v12 offset:40960
    ds_read_b128 v[108:111], v13 offset:40960
    ds_read_b128 v[112:115], v12 offset:49152
    ds_read_b128 v[116:119], v13 offset:49152
    ds_read_b128 v[120:123], v12 offset:57344
    ds_read_b128 v[124:127], v13 offset:57344
    s_waitcnt lgkmcnt(6)
    v_pk_add_f32 v[88:89], v[88:89], v[96:97]
    v_pk_add_f32 v[90:91], v[90:91], v[98:99]
    v_pk_add_f32 v[92:93], v[92:93], v[100:101]
    v_pk_add_f32 v[94:95], v[94:95], v[102:103]
    s_waitcnt lgkmcnt(4)
    v_pk_add_f32 v[88:89], v[88:89], v[104:105]
    v_pk_add_f32 v[90:91], v[90:91], v[106:107]
    v_pk_add_f32 v[92:93], v[92:93], v[108:109]
    v_pk_add_f32 v[94:95], v[94:95], v[110:111]
    s_waitcnt lgkmcnt(2)
    v_pk_add_f32 v[88:89], v[88:89], v[112:113]
    v_pk_add_f32 v[90:91], v[90:91], v[114:115]
    v_pk_add_f32 v[92:93], v[92:93], v[116:117]
    v_pk_add_f32 v[94:95], v[94:95], v[118:119]
    s_waitcnt lgkmcnt(0)
    v_pk_add_f32 v[88:89], v[88:89], v[120:121]
    v_pk_add_f32 v[90:91], v[90:91], v[122:123]
    v_pk_add_f32 v[92:93], v[92:93], v[124:125]
    v_pk_add_f32 v[94:95], v[94:95], v[126:127]
    s_waitcnt vmcnt(0)
    v_pk_fma_f32 v[88:89], v[88:89], v[24:25], v[40:41]
    v_pk_fma_f32 v[90:91], v[90:91], v[26:27], v[42:43]
    v_pk_fma_f32 v[92:93], v[92:93], v[28:29], v[44:45]
    v_pk_fma_f32 v[94:95], v[94:95], v[30:31], v[46:47]
    v_cvt_pk_bf16_f32 v64, v88, v89
    v_cvt_pk_bf16_f32 v65, v90, v91
    v_cvt_pk_bf16_f32 v66, v92, v93
    v_cvt_pk_bf16_f32 v67, v94, v95
    buffer_store_dwordx4 v[64:67], v9, s[12:15], s57 offen sc1
KB_end:
    s_endpgm
code_end:
.section .rodata,"a"
.p2align 6
.amdhsa_kernel adaLN_cond__spectral_fnet__geglu_ffn__prompt_kernel
  .amdhsa_next_free_vgpr 256
  .amdhsa_next_free_sgpr 102
  .amdhsa_accum_offset 144
  .amdhsa_group_segment_fixed_size 0
  .amdhsa_kernarg_size 112
  .amdhsa_user_sgpr_count 2
  .amdhsa_user_sgpr_kernarg_segment_ptr 1
  .amdhsa_system_sgpr_workgroup_id_x 1
  .amdhsa_float_denorm_mode_32 3
  .amdhsa_float_denorm_mode_16_64 3
.end_amdhsa_kernel
```
